```python
import torch

def _softmax(x, axis=-1):
    return torch.softmax(x, dim=axis)
def _gelu(x):
    return torch.nn.functional.gelu(x, approximate="tanh")
def _silu(x):
    return torch.nn.functional.silu(x)
def _sigmoid(x):
    return torch.sigmoid(x)
def _layernorm(x, axis=-1, eps=1e-5):
    m = x.mean(dim=axis, keepdim=True)
    v = x.var(dim=axis, keepdim=True, unbiased=False)
    return (x - m) / torch.sqrt(v + eps)
def _scatter_add(tgt, idx, src, axis=0):
    return tgt.clone().index_add_(axis, idx, src)
def _segment_sum(src, seg, n):
    out = torch.zeros((n,) + src.shape[1:], dtype=src.dtype)
    return out.index_add_(0, seg, src)
def _pad(x, pw):
    flat = tuple(v for pair in reversed(pw) for v in pair)
    return torch.nn.functional.pad(x, flat)

kernel_name = 'concat_heads__gqa_block_cached__mha_block_cached__near_ridge'

def setup_inputs():

    _w = (lambda a: (lambda t: t.to(torch.bfloat16) if t.is_floating_point() else t)(torch.as_tensor(a)))
    def _A_setup():
        B, Sq, D = 8, 80, 512
        Hq, Hkv, Sk, Dh = 32, 8, 1024, 128
        assert Hq % Hkv == 0, (Hq, Hkv)
        return {
            "x": _w((lambda *s: torch.randn(*s, dtype=torch.bfloat16) * 0.8)(B, Sq, D)),
            "k_cache": _w((lambda *s: torch.randn(*s, dtype=torch.bfloat16) * 0.8)(B, Hkv, Sk, Dh)),
            "v_cache": _w((lambda *s: torch.randn(*s, dtype=torch.bfloat16) * 0.05)(B, Hkv, Sk, Dh)),
            "wq": _w((lambda *s: torch.randn(*s, dtype=torch.bfloat16) * 0.8)(D, Hq * Dh) * (D ** -0.5)),
            "wo": _w((lambda *s: torch.randn(*s, dtype=torch.bfloat16) * 0.05)(Hq * Dh, D) * ((Hq * Dh) ** -0.5)),
        }
    _A_in = _A_setup()

    def _B_setup():
        B, Sq, D = 8, 80, 512
        H, Sk, Dh = 32, 1024, 128
        return {
            "x": _w((lambda *s: torch.randn(*s, dtype=torch.bfloat16) * 0.8)(B, Sq, D)),
            "k_cache": _w((lambda *s: torch.randn(*s, dtype=torch.bfloat16) * 0.8)(B, H, Sk, Dh)),
            "v_cache": _w((lambda *s: torch.randn(*s, dtype=torch.bfloat16) * 0.05)(B, H, Sk, Dh)),
            "wq": _w((lambda *s: torch.randn(*s, dtype=torch.bfloat16) * 0.8)(D, H * Dh) * (D ** -0.5)),
            "wo": _w((lambda *s: torch.randn(*s, dtype=torch.bfloat16) * 0.05)(H * Dh, D) * ((H * Dh) ** -0.5)),
        }
    _B_in = _B_setup()

    return {
        "A_x": _A_in["x"],
        "A_k_cache": _A_in["k_cache"],
        "A_v_cache": _A_in["v_cache"],
        "A_wq": _A_in["wq"],
        "A_wo": _A_in["wo"],
        "B_x": _B_in["x"],
        "B_k_cache": _B_in["k_cache"],
        "B_v_cache": _B_in["v_cache"],
        "B_wq": _B_in["wq"],
        "B_wo": _B_in["wo"],
    }

def reference(A_x, A_k_cache, A_v_cache, A_wq, A_wo, B_x, B_k_cache, B_v_cache, B_wq, B_wo):
    def _A_ref(x, k_cache, v_cache, wq, wo):
        B, Sq, D = x.shape
        Hq, Dh = 32, 128
        Hkv = k_cache.shape[1]
        rep = Hq // Hkv
        q = (lambda x, *d: x.permute(*d))((x @ wq).reshape(B, Sq, Hq, Dh), 0, 2, 1, 3)
        k = (lambda x, n, axis: torch.repeat_interleave(x, n, dim=axis))(k_cache, rep, axis=1)
        v = (lambda x, n, axis: torch.repeat_interleave(x, n, dim=axis))(v_cache, rep, axis=1)
        scores = torch.einsum("bhqd,bhkd->bhqk", q, k) * (Dh ** -0.5)
        p = _softmax(scores, axis=-1)
        o = torch.einsum("bhqk,bhkd->bhqd", p, v)
        return (lambda x, *d: x.permute(*d))(o, 0, 2, 1, 3).reshape(B, Sq, Hq * Dh) @ wo

    def _B_ref(x, k_cache, v_cache, wq, wo):
        B, Sq, D = x.shape
        H, Dh = 32, 128
        q = (lambda x, *d: x.permute(*d))((x @ wq).reshape(B, Sq, H, Dh), 0, 2, 1, 3)
        scores = torch.einsum("bhqd,bhkd->bhqk", q, k_cache) * (Dh ** -0.5)
        p = _softmax(scores, axis=-1)
        o = torch.einsum("bhqk,bhkd->bhqd", p, v_cache)
        return (lambda x, *d: x.permute(*d))(o, 0, 2, 1, 3).reshape(B, Sq, H * Dh) @ wo

    a = _A_ref(A_x, A_k_cache, A_v_cache, A_wq, A_wo)
    b = _B_ref(B_x, B_k_cache, B_v_cache, B_wq, B_wo)
    return torch.concatenate([a, b], axis=-1)
```

```asm
; @launch grid=(256,1,1) block=(256,1,1) lds=163840
.amdgcn_target "amdgcn-amd-amdhsa--gfx950"
.text
.globl concat_heads__gqa_block_cached__mha_block_cached__near_ridge_kernel
.p2align 8
.type concat_heads__gqa_block_cached__mha_block_cached__near_ridge_kernel,@function
concat_heads__gqa_block_cached__mha_block_cached__near_ridge_kernel:
    s_cmp_ge_u32 s2, 256
    s_cbranch_scc1 L_exit
    s_load_dwordx16 s[36:51], s[0:1], 0
    s_load_dwordx8 s[52:59], s[0:1], 64
    s_load_dwordx2 s[60:61], s[0:1], 96
    v_lshrrev_b32 v1, 6, v0
    v_and_b32 v0, 63, v0
    v_readfirstlane_b32 s24, v1
    s_and_b32 s30, s2, 7
    s_lshr_b32 s31, s2, 3
    s_cmp_lt_u32 s31, 16
    s_cselect_b32 s64, 1, 0
    s_and_b32 s32, s31, 1
    s_bfe_u32 s63, s31, 0x30001
    s_lshl_b32 s30, s30, 2
    s_lshl_b32 s29, s32, 1
    s_add_u32 s62, s30, s29
    s_lshl_b32 s29, s64, 2
    s_xor_b32 s62, s62, s29
    s_lshl_b32 s66, s63, 1
    s_lshl_b32 s32, s32, 3
    s_xor_b32 s66, s66, s32
    s_lshl_b32 s32, s64, 2
    s_xor_b32 s66, s66, s32
    s_lshl_b32 s68, s24, 15
    s_and_b32 s35, s24, 1
    s_lshr_b32 s65, s24, 1
    s_mov_b32 s34, 0x3e0293ee
    s_lshl_b32 s69, s24, 10
    s_and_b32 s29, s2, 7
    s_mul_i32 s29, s29, 5
    s_mul_i32 s30, s63, 3
    s_add_u32 s29, s29, s30
    s_lshl_b32 s30, s35, 3
    s_add_u32 s29, s29, s30
    s_lshr_b32 s30, s62, 1
    s_mul_i32 s30, s30, 7
    s_lshl_b32 s31, s65, 2
    s_add_u32 s30, s30, s31
    s_mul_i32 s30, s30, s64
    s_add_u32 s29, s29, s30
    s_and_b32 s29, s29, 15
    s_lshl_b32 s3, s29, 13
    v_lshrrev_b32 v1, 4, v0
    v_and_b32 v2, 15, v0
    v_lshlrev_b32 v33, 4, v0
    v_xor_b32 v5, v2, v1
    v_lshlrev_b32 v6, 8, v1
    v_xor_b32 v7, 0, v5
    v_lshl_add_u32 v40, v7, 4, v6
    v_xor_b32 v7, 4, v5
    v_lshl_add_u32 v41, v7, 4, v6
    v_xor_b32 v7, 8, v5
    v_lshl_add_u32 v42, v7, 4, v6
    v_xor_b32 v7, 12, v5
    v_lshl_add_u32 v43, v7, 4, v6
    v_lshlrev_b32 v7, 1, v1
    v_xor_b32 v5, v2, v7
    v_xor_b32 v7, 0, v5
    v_lshl_add_u32 v44, v7, 4, v6
    v_xor_b32 v7, 8, v5
    v_lshl_add_u32 v45, v7, 4, v6
    s_lshl_b32 s29, s24, 2
    v_add_u32 v3, s29, v1
    v_xor_b32 v4, v3, v2
    v_lshlrev_b32 v4, 4, v4
    v_lshl_add_u32 v58, v3, 10, v4
    v_lshrrev_b32 v3, 5, v0
    v_lshlrev_b32 v3, 1, v3
    v_xor_b32 v3, v3, v0
    v_and_b32 v3, 3, v3
    v_lshlrev_b32 v3, 4, v3
    v_lshrrev_b32 v4, 2, v0
    v_lshl_add_u32 v16, v4, 13, v3
    v_add_u32 v17, 130048, v16
    v_add_u32 v18, 260096, v16
    v_add_u32 v19, 390144, v16
    s_mul_i32 s32, s63, 81920
    s_xor_b32 s29, s62, 4
    s_add_u32 s29, s29, 1
    s_cmp_eq_u32 s64, 1
    s_cselect_b32 s29, s62, s29
    s_lshl_b32 s29, s29, 8
    s_lshl_b32 s30, s24, 6
    s_add_u32 s29, s29, s30
    s_lshl_b32 s30, s63, 5
    s_add_u32 s30, s30, s62
    s_add_u32 s30, s30, s65
    s_lshr_b32 s31, s30, 2
    s_cmp_eq_u32 s64, 1
    s_cselect_b32 s31, s30, s31
    s_lshl_b32 s31, s31, 18
    s_lshl_b32 s73, s35, 17
    s_add_u32 s31, s31, s73
    s_waitcnt lgkmcnt(0)
    s_add_u32 s12, s46, s32
    s_addc_u32 s13, s47, 0
    s_and_b32 s13, s13, 0xffff
    s_mov_b32 s14, 81920
    s_mov_b32 s15, 0x20000
    s_add_u32 s16, s52, s29
    s_addc_u32 s17, s53, 0
    s_and_b32 s17, s17, 0xffff
    s_sub_u32 s18, 0x400000, s29
    s_mov_b32 s19, 0x20000
    s_add_u32 m0, s69, 0
    s_lshr_b32 s67, s66, 2
    s_xor_b32 s67, s67, 0
    s_lshl_b32 s67, s67, 8
    buffer_load_dwordx4 v58, s[12:15], s67 offen lds
    s_add_u32 m0, s69, 32768
    s_add_u32 s67, s67, 16384
    buffer_load_dwordx4 v58, s[12:15], s67 offen lds
    s_add_u32 m0, s69, 65536
    s_add_u32 s67, s67, 16384
    buffer_load_dwordx4 v58, s[12:15], s67 offen lds
    s_add_u32 m0, s69, 98304
    s_add_u32 s67, s67, 16384
    buffer_load_dwordx4 v58, s[12:15], s67 offen lds
    s_add_u32 m0, s69, 131072
    s_add_u32 s67, s67, 16384
    buffer_load_dwordx4 v58, s[12:15], s67 offen lds
    s_add_u32 m0, s68, 16384
    s_xor_b32 s33, s66, 0
    s_lshl_b32 s33, s33, 18
    buffer_load_dwordx4 v16, s[16:19], s33 offen offset:0 lds
    buffer_load_dwordx4 v17, s[16:19], s33 offen offset:1024 lds
    buffer_load_dwordx4 v18, s[16:19], s33 offen offset:2048 lds
    buffer_load_dwordx4 v19, s[16:19], s33 offen offset:3072 lds
    s_add_u32 m0, s68, 20480
    s_xor_b32 s33, s66, 2
    s_lshl_b32 s33, s33, 18
    buffer_load_dwordx4 v16, s[16:19], s33 offen offset:0 lds
    buffer_load_dwordx4 v17, s[16:19], s33 offen offset:1024 lds
    buffer_load_dwordx4 v18, s[16:19], s33 offen offset:2048 lds
    buffer_load_dwordx4 v19, s[16:19], s33 offen offset:3072 lds
    s_mov_b32 s76, s58
    s_and_b32 s77, s59, 0xffff
    s_mov_b32 s78, 256
    s_mov_b32 s79, 0x20000
    s_or_b32 s73, s2, s24
    s_cmp_lg_u32 s73, 0
    s_cbranch_scc1 L_notag
    s_memrealtime s[74:75]
    s_waitcnt lgkmcnt(0)
    s_or_b32 s74, s74, 1
    v_mov_b32 v8, s74
    v_mov_b32 v9, s75
    v_mov_b32 v10, 0
    s_mov_b64 exec, 1
    buffer_store_dwordx2 v[8:9], v10, s[76:79], 0 offen sc0 sc1
    s_mov_b64 exec, -1
    s_waitcnt vmcnt(0)
L_notag:
    s_cmp_eq_u32 s64, 1
    s_cselect_b64 s[74:75], s[48:49], s[38:39]
    s_add_u32 s4, s74, s31
    s_addc_u32 s5, s75, 0
    s_and_b32 s5, s5, 0xffff
    s_mov_b32 s6, 131072
    s_mov_b32 s7, 0x20000
    s_cmp_eq_u32 s64, 1
    s_cselect_b64 s[74:75], s[50:51], s[40:41]
    s_add_u32 s8, s74, s31
    s_addc_u32 s9, s75, 0
    s_and_b32 s9, s9, 0xffff
    s_mov_b32 s10, 131072
    s_mov_b32 s11, 0x20000
    s_add_u32 s88, s36, s32
    s_addc_u32 s89, s37, 0
    s_and_b32 s89, s89, 0xffff
    s_mov_b32 s90, 81920
    s_mov_b32 s91, 0x20000
    s_lshl_b32 s29, s62, 8
    s_lshl_b32 s30, s24, 7
    s_add_u32 s29, s29, s30
    s_add_u32 s92, s42, s29
    s_addc_u32 s93, s43, 0
    s_and_b32 s93, s93, 0xffff
    s_sub_u32 s94, 0x400000, s29
    s_mov_b32 s95, 0x20000
    s_and_b32 s29, s2, 127
    s_lshl_b32 s96, s29, 7
    s_add_u32 s96, s96, 65536
    s_mul_i32 s29, s29, 20480
    s_add_u32 s29, s29, 41943040
    s_add_u32 s20, s60, s29
    s_addc_u32 s21, s61, 0
    s_and_b32 s21, s21, 0xffff
    s_mov_b32 s22, 20480
    s_mov_b32 s23, 0x20000
    s_mov_b32 s29, 33554432
    s_add_u32 s80, s60, s29
    s_addc_u32 s81, s61, 0
    s_and_b32 s81, s81, 0xffff
    s_mov_b32 s82, 1048576
    s_mov_b32 s83, 0x20000
    v_lshrrev_b32 v5, 2, v2
    v_lshl_add_u32 v6, v1, 3, v5
    v_and_b32 v7, 1, v1
    v_lshlrev_b32 v7, 1, v7
    v_bfe_u32 v5, v2, 1, 1
    v_xor_b32 v5, v5, v7
    v_lshlrev_b32 v5, 4, v5
    v_lshl_add_u32 v5, v6, 6, v5
    v_and_b32 v7, 1, v2
    v_lshl_add_u32 v5, v7, 3, v5
    v_add_u32 v5, s68, v5
    v_add_u32 v20, 16384, v5
    v_xor_b32 v21, 32, v20
    v_xor_b32 v5, v1, v2
    v_lshlrev_b32 v5, 4, v5
    v_lshl_add_u32 v5, v2, 8, v5
    s_and_b32 s29, s66, 3
    s_lshl_b32 s29, s29, 6
    v_xor_b32 v5, s29, v5
    v_xor_b32 v26, 0, v5
    v_add_u32 v8, 65536, v26
    v_add_u32 v22, 131072, v26
    v_xor_b32 v27, 64, v5
    v_add_u32 v9, 65536, v27
    v_add_u32 v23, 131072, v27
    v_xor_b32 v28, 128, v5
    v_add_u32 v10, 65536, v28
    v_add_u32 v24, 131072, v28
    v_xor_b32 v29, 192, v5
    v_add_u32 v11, 65536, v29
    v_add_u32 v25, 131072, v29
    v_lshrrev_b32 v5, 1, v1
    v_lshlrev_b32 v5, 8, v5
    v_lshl_add_u32 v5, v2, 4, v5
    v_and_b32 v7, 1, v1
    v_lshl_add_u32 v30, v7, 3, v5
    s_add_u32 m0, s69, 4096
    s_lshr_b32 s67, s66, 2
    s_xor_b32 s67, s67, 1
    s_lshl_b32 s67, s67, 8
    buffer_load_dwordx4 v58, s[12:15], s67 offen lds
    s_add_u32 m0, s69, 36864
    s_add_u32 s67, s67, 16384
    buffer_load_dwordx4 v58, s[12:15], s67 offen lds
    s_add_u32 m0, s69, 69632
    s_add_u32 s67, s67, 16384
    buffer_load_dwordx4 v58, s[12:15], s67 offen lds
    s_add_u32 m0, s69, 102400
    s_add_u32 s67, s67, 16384
    buffer_load_dwordx4 v58, s[12:15], s67 offen lds
    s_add_u32 m0, s69, 135168
    s_add_u32 s67, s67, 16384
    buffer_load_dwordx4 v58, s[12:15], s67 offen lds
    s_add_u32 m0, s68, 24576
    s_xor_b32 s33, s66, 4
    s_lshl_b32 s33, s33, 18
    buffer_load_dwordx4 v16, s[16:19], s33 offen offset:0 lds
    buffer_load_dwordx4 v17, s[16:19], s33 offen offset:1024 lds
    buffer_load_dwordx4 v18, s[16:19], s33 offen offset:2048 lds
    buffer_load_dwordx4 v19, s[16:19], s33 offen offset:3072 lds
    s_add_u32 m0, s68, 28672
    s_xor_b32 s33, s66, 6
    s_lshl_b32 s33, s33, 18
    buffer_load_dwordx4 v16, s[16:19], s33 offen offset:0 lds
    buffer_load_dwordx4 v17, s[16:19], s33 offen offset:1024 lds
    buffer_load_dwordx4 v18, s[16:19], s33 offen offset:2048 lds
    buffer_load_dwordx4 v19, s[16:19], s33 offen offset:3072 lds
    s_lshl_b32 s29, s35, 16
    s_cmp_eq_u32 s64, 1
    s_cselect_b32 s25, s68, s29
    v_xor_b32 v5, v1, v2
    v_lshlrev_b32 v5, 4, v5
    v_lshl_add_u32 v5, v2, 8, v5
    s_lshl_b32 s29, s35, 7
    s_cmp_eq_u32 s64, 1
    s_cselect_b32 s30, 0, s29
    v_xor_b32 v5, s30, v5
    v_add_u32 v5, s25, v5
    v_xor_b32 v46, 0, v5
    v_xor_b32 v47, 64, v5
    v_xor_b32 v48, 128, v5
    v_xor_b32 v49, 192, v5
    v_lshrrev_b32 v5, 2, v2
    v_lshl_add_u32 v5, v1, 2, v5
    v_and_b32 v6, 7, v5
    v_lshlrev_b32 v6, 1, v6
    v_bfe_u32 v7, v2, 1, 1
    v_xor_b32 v6, v6, v7
    v_lshlrev_b32 v6, 4, v6
    v_lshl_add_u32 v6, v5, 8, v6
    v_and_b32 v7, 1, v2
    v_lshl_add_u32 v6, v7, 3, v6
    v_xor_b32 v6, s29, v6
    v_add_u32 v6, s25, v6
    v_xor_b32 v50, 0, v6
    v_xor_b32 v51, 32, v6
    v_xor_b32 v52, 64, v6
    v_xor_b32 v53, 96, v6
    v_xor_b32 v54, 128, v6
    v_xor_b32 v55, 160, v6
    v_xor_b32 v56, 192, v6
    v_xor_b32 v57, 224, v6
    v_mov_b32 v60, 0x3f803f80
    v_mov_b32 v61, 0x3f803f80
    v_mov_b32 v62, 0x3f803f80
    v_mov_b32 v63, 0x3f803f80
    v_lshrrev_b32 v3, 3, v0
    v_and_b32 v4, 7, v0
    v_and_b32 v5, 2, v3
    v_xor_b32 v4, v4, v5
    v_lshlrev_b32 v4, 4, v4
    v_lshl_add_u32 v12, v3, 13, v4
    v_xor_b32 v4, 64, v12
    v_add_u32 v13, 64512, v4
    v_add_u32 v14, 129024, v12
    v_add_u32 v15, 193536, v4
    v_mov_b32 v6, s34
    v_mov_b32 v7, s34
    v_accvgpr_write_b32 a0, 0
    v_accvgpr_write_b32 a1, 0
    v_accvgpr_write_b32 a2, 0
    v_accvgpr_write_b32 a3, 0
    v_accvgpr_write_b32 a4, 0
    v_accvgpr_write_b32 a5, 0
    v_accvgpr_write_b32 a6, 0
    v_accvgpr_write_b32 a7, 0
    v_accvgpr_write_b32 a8, 0
    v_accvgpr_write_b32 a9, 0
    v_accvgpr_write_b32 a10, 0
    v_accvgpr_write_b32 a11, 0
    v_accvgpr_write_b32 a12, 0
    v_accvgpr_write_b32 a13, 0
    v_accvgpr_write_b32 a14, 0
    v_accvgpr_write_b32 a15, 0
    v_accvgpr_write_b32 a16, 0
    v_accvgpr_write_b32 a17, 0
    v_accvgpr_write_b32 a18, 0
    v_accvgpr_write_b32 a19, 0
    v_accvgpr_write_b32 a20, 0
    v_accvgpr_write_b32 a21, 0
    v_accvgpr_write_b32 a22, 0
    v_accvgpr_write_b32 a23, 0
    v_accvgpr_write_b32 a24, 0
    v_accvgpr_write_b32 a25, 0
    v_accvgpr_write_b32 a26, 0
    v_accvgpr_write_b32 a27, 0
    v_accvgpr_write_b32 a28, 0
    v_accvgpr_write_b32 a29, 0
    v_accvgpr_write_b32 a30, 0
    v_accvgpr_write_b32 a31, 0
    v_accvgpr_write_b32 a32, 0
    v_accvgpr_write_b32 a33, 0
    v_accvgpr_write_b32 a34, 0
    v_accvgpr_write_b32 a35, 0
    v_accvgpr_write_b32 a36, 0
    v_accvgpr_write_b32 a37, 0
    v_accvgpr_write_b32 a38, 0
    v_accvgpr_write_b32 a39, 0
    v_accvgpr_write_b32 a40, 0
    v_accvgpr_write_b32 a41, 0
    v_accvgpr_write_b32 a42, 0
    v_accvgpr_write_b32 a43, 0
    v_accvgpr_write_b32 a44, 0
    v_accvgpr_write_b32 a45, 0
    v_accvgpr_write_b32 a46, 0
    v_accvgpr_write_b32 a47, 0
    v_accvgpr_write_b32 a48, 0
    v_accvgpr_write_b32 a49, 0
    v_accvgpr_write_b32 a50, 0
    v_accvgpr_write_b32 a51, 0
    v_accvgpr_write_b32 a52, 0
    v_accvgpr_write_b32 a53, 0
    v_accvgpr_write_b32 a54, 0
    v_accvgpr_write_b32 a55, 0
    v_accvgpr_write_b32 a56, 0
    v_accvgpr_write_b32 a57, 0
    v_accvgpr_write_b32 a58, 0
    v_accvgpr_write_b32 a59, 0
    v_accvgpr_write_b32 a60, 0
    v_accvgpr_write_b32 a61, 0
    v_accvgpr_write_b32 a62, 0
    v_accvgpr_write_b32 a63, 0
    v_accvgpr_write_b32 a64, 0
    v_accvgpr_write_b32 a65, 0
    v_accvgpr_write_b32 a66, 0
    v_accvgpr_write_b32 a67, 0
    v_accvgpr_write_b32 a68, 0
    v_accvgpr_write_b32 a69, 0
    v_accvgpr_write_b32 a70, 0
    v_accvgpr_write_b32 a71, 0
    v_accvgpr_write_b32 a72, 0
    v_accvgpr_write_b32 a73, 0
    v_accvgpr_write_b32 a74, 0
    v_accvgpr_write_b32 a75, 0
    v_accvgpr_write_b32 a76, 0
    v_accvgpr_write_b32 a77, 0
    v_accvgpr_write_b32 a78, 0
    v_accvgpr_write_b32 a79, 0
    v_accvgpr_write_b32 a80, 0
    v_accvgpr_write_b32 a81, 0
    v_accvgpr_write_b32 a82, 0
    v_accvgpr_write_b32 a83, 0
    v_accvgpr_write_b32 a84, 0
    v_accvgpr_write_b32 a85, 0
    v_accvgpr_write_b32 a86, 0
    v_accvgpr_write_b32 a87, 0
    v_accvgpr_write_b32 a88, 0
    v_accvgpr_write_b32 a89, 0
    v_accvgpr_write_b32 a90, 0
    v_accvgpr_write_b32 a91, 0
    v_accvgpr_write_b32 a92, 0
    v_accvgpr_write_b32 a93, 0
    v_accvgpr_write_b32 a94, 0
    v_accvgpr_write_b32 a95, 0
    v_accvgpr_write_b32 a96, 0
    v_accvgpr_write_b32 a97, 0
    v_accvgpr_write_b32 a98, 0
    v_accvgpr_write_b32 a99, 0
    v_accvgpr_write_b32 a100, 0
    v_accvgpr_write_b32 a101, 0
    v_accvgpr_write_b32 a102, 0
    v_accvgpr_write_b32 a103, 0
    v_accvgpr_write_b32 a104, 0
    v_accvgpr_write_b32 a105, 0
    v_accvgpr_write_b32 a106, 0
    v_accvgpr_write_b32 a107, 0
    v_accvgpr_write_b32 a108, 0
    v_accvgpr_write_b32 a109, 0
    v_accvgpr_write_b32 a110, 0
    v_accvgpr_write_b32 a111, 0
    v_accvgpr_write_b32 a112, 0
    v_accvgpr_write_b32 a113, 0
    v_accvgpr_write_b32 a114, 0
    v_accvgpr_write_b32 a115, 0
    v_accvgpr_write_b32 a116, 0
    v_accvgpr_write_b32 a117, 0
    v_accvgpr_write_b32 a118, 0
    v_accvgpr_write_b32 a119, 0
    v_accvgpr_write_b32 a120, 0
    v_accvgpr_write_b32 a121, 0
    v_accvgpr_write_b32 a122, 0
    v_accvgpr_write_b32 a123, 0
    v_accvgpr_write_b32 a124, 0
    v_accvgpr_write_b32 a125, 0
    v_accvgpr_write_b32 a126, 0
    v_accvgpr_write_b32 a127, 0
    v_accvgpr_write_b32 a128, 0
    v_accvgpr_write_b32 a129, 0
    v_accvgpr_write_b32 a130, 0
    v_accvgpr_write_b32 a131, 0
    v_accvgpr_write_b32 a132, 0
    v_accvgpr_write_b32 a133, 0
    v_accvgpr_write_b32 a134, 0
    v_accvgpr_write_b32 a135, 0
    v_accvgpr_write_b32 a136, 0
    v_accvgpr_write_b32 a137, 0
    v_accvgpr_write_b32 a138, 0
    v_accvgpr_write_b32 a139, 0
    v_accvgpr_write_b32 a140, 0
    v_accvgpr_write_b32 a141, 0
    v_accvgpr_write_b32 a142, 0
    v_accvgpr_write_b32 a143, 0
    v_accvgpr_write_b32 a144, 0
    v_accvgpr_write_b32 a145, 0
    v_accvgpr_write_b32 a146, 0
    v_accvgpr_write_b32 a147, 0
    v_accvgpr_write_b32 a148, 0
    v_accvgpr_write_b32 a149, 0
    v_accvgpr_write_b32 a150, 0
    v_accvgpr_write_b32 a151, 0
    v_accvgpr_write_b32 a152, 0
    v_accvgpr_write_b32 a153, 0
    v_accvgpr_write_b32 a154, 0
    v_accvgpr_write_b32 a155, 0
    v_accvgpr_write_b32 a156, 0
    v_accvgpr_write_b32 a157, 0
    v_accvgpr_write_b32 a158, 0
    v_accvgpr_write_b32 a159, 0
    s_waitcnt vmcnt(17)
    s_barrier
    ds_read_b128 v[64:67], v26 offset:0
    ds_read_b128 v[68:71], v26 offset:32768
    ds_read_b128 v[72:75], v8 offset:0
    ds_read_b128 v[76:79], v8 offset:32768
    ds_read_b128 v[80:83], v22 offset:0
    ds_read_b128 v[84:87], v27 offset:0
    ds_read_b128 v[88:91], v27 offset:32768
    ds_read_b128 v[92:95], v9 offset:0
    ds_read_b128 v[96:99], v9 offset:32768
    ds_read_b128 v[100:103], v23 offset:0
    ds_read_b64_tr_b16 v[144:145], v20 offset:0
    ds_read_b64_tr_b16 v[146:147], v20 offset:256
    ds_read_b64_tr_b16 v[148:149], v21 offset:0
    ds_read_b64_tr_b16 v[150:151], v21 offset:256
    ds_read_b64_tr_b16 v[152:153], v20 offset:2048
    ds_read_b64_tr_b16 v[154:155], v20 offset:2304
    ds_read_b64_tr_b16 v[156:157], v21 offset:2048
    ds_read_b64_tr_b16 v[158:159], v21 offset:2304
    s_waitcnt vmcnt(13)
    s_waitcnt lgkmcnt(0)
    v_mfma_f32_16x16x32_bf16 v[176:179], v[144:147], v[64:67], 0
    ds_read_b128 v[104:107], v28 offset:0
    ds_read_b128 v[108:111], v28 offset:32768
    v_mfma_f32_16x16x32_bf16 v[196:199], v[148:151], v[64:67], 0
    ds_read_b128 v[112:115], v10 offset:0
    ds_read_b128 v[116:119], v10 offset:32768
    v_mfma_f32_16x16x32_bf16 v[180:183], v[144:147], v[68:71], 0
    ds_read_b128 v[120:123], v24 offset:0
    v_mfma_f32_16x16x32_bf16 v[200:203], v[148:151], v[68:71], 0
    ds_read_b128 v[124:127], v29 offset:0
    ds_read_b128 v[128:131], v29 offset:32768
    v_mfma_f32_16x16x32_bf16 v[184:187], v[144:147], v[72:75], 0
    ds_read_b128 v[132:135], v11 offset:0
    ds_read_b128 v[136:139], v11 offset:32768
    v_mfma_f32_16x16x32_bf16 v[204:207], v[148:151], v[72:75], 0
    ds_read_b128 v[140:143], v25 offset:0
    ds_read_b64_tr_b16 v[160:161], v20 offset:4096
    v_mfma_f32_16x16x32_bf16 v[188:191], v[144:147], v[76:79], 0
    ds_read_b64_tr_b16 v[162:163], v20 offset:4352
    ds_read_b64_tr_b16 v[164:165], v21 offset:4096
    v_mfma_f32_16x16x32_bf16 v[208:211], v[148:151], v[76:79], 0
    ds_read_b64_tr_b16 v[166:167], v21 offset:4352
    v_mfma_f32_16x16x32_bf16 v[192:195], v[144:147], v[80:83], 0
    ds_read_b64_tr_b16 v[168:169], v20 offset:6144
    ds_read_b64_tr_b16 v[170:171], v20 offset:6400
    v_mfma_f32_16x16x32_bf16 v[212:215], v[148:151], v[80:83], 0
    ds_read_b64_tr_b16 v[172:173], v21 offset:6144
    ds_read_b64_tr_b16 v[174:175], v21 offset:6400
    v_mfma_f32_16x16x32_bf16 v[176:179], v[152:155], v[84:87], v[176:179]
    s_add_u32 m0, s69, 8192
    s_lshr_b32 s67, s66, 2
    s_xor_b32 s67, s67, 2
    s_lshl_b32 s67, s67, 8
    buffer_load_dwordx4 v58, s[12:15], s67 offen lds
    v_mfma_f32_16x16x32_bf16 v[196:199], v[156:159], v[84:87], v[196:199]
    s_add_u32 m0, s69, 40960
    s_add_u32 s67, s67, 16384
    buffer_load_dwordx4 v58, s[12:15], s67 offen lds
    v_mfma_f32_16x16x32_bf16 v[180:183], v[152:155], v[88:91], v[180:183]
    s_add_u32 m0, s69, 73728
    s_add_u32 s67, s67, 16384
    buffer_load_dwordx4 v58, s[12:15], s67 offen lds
    v_mfma_f32_16x16x32_bf16 v[200:203], v[156:159], v[88:91], v[200:203]
    s_add_u32 m0, s69, 106496
    s_add_u32 s67, s67, 16384
    buffer_load_dwordx4 v58, s[12:15], s67 offen lds
    v_mfma_f32_16x16x32_bf16 v[184:187], v[152:155], v[92:95], v[184:187]
    s_add_u32 m0, s69, 139264
    s_add_u32 s67, s67, 16384
    buffer_load_dwordx4 v58, s[12:15], s67 offen lds
    v_mfma_f32_16x16x32_bf16 v[204:207], v[156:159], v[92:95], v[204:207]
    v_mfma_f32_16x16x32_bf16 v[188:191], v[152:155], v[96:99], v[188:191]
    s_add_u32 m0, s68, 16384
    s_xor_b32 s33, s66, 8
    s_lshl_b32 s33, s33, 18
    buffer_load_dwordx4 v16, s[16:19], s33 offen offset:0 lds
    v_mfma_f32_16x16x32_bf16 v[208:211], v[156:159], v[96:99], v[208:211]
    buffer_load_dwordx4 v17, s[16:19], s33 offen offset:1024 lds
    v_mfma_f32_16x16x32_bf16 v[192:195], v[152:155], v[100:103], v[192:195]
    buffer_load_dwordx4 v18, s[16:19], s33 offen offset:2048 lds
    v_mfma_f32_16x16x32_bf16 v[212:215], v[156:159], v[100:103], v[212:215]
    buffer_load_dwordx4 v19, s[16:19], s33 offen offset:3072 lds
    s_waitcnt vmcnt(13)
    s_waitcnt lgkmcnt(0)
    s_barrier
    v_mfma_f32_16x16x32_bf16 v[176:179], v[160:163], v[104:107], v[176:179]
    ds_read_b128 v[64:67], v26 offset:4096
    ds_read_b128 v[68:71], v26 offset:36864
    v_mfma_f32_16x16x32_bf16 v[196:199], v[164:167], v[104:107], v[196:199]
    ds_read_b128 v[72:75], v8 offset:4096
    ds_read_b128 v[76:79], v8 offset:36864
    v_mfma_f32_16x16x32_bf16 v[180:183], v[160:163], v[108:111], v[180:183]
    ds_read_b128 v[80:83], v22 offset:4096
    v_mfma_f32_16x16x32_bf16 v[200:203], v[164:167], v[108:111], v[200:203]
    ds_read_b128 v[84:87], v27 offset:4096
    ds_read_b128 v[88:91], v27 offset:36864
    v_mfma_f32_16x16x32_bf16 v[184:187], v[160:163], v[112:115], v[184:187]
    ds_read_b128 v[92:95], v9 offset:4096
    ds_read_b128 v[96:99], v9 offset:36864
    v_mfma_f32_16x16x32_bf16 v[204:207], v[164:167], v[112:115], v[204:207]
    ds_read_b128 v[100:103], v23 offset:4096
    ds_read_b64_tr_b16 v[144:145], v20 offset:8192
    v_mfma_f32_16x16x32_bf16 v[188:191], v[160:163], v[116:119], v[188:191]
    ds_read_b64_tr_b16 v[146:147], v20 offset:8448
    ds_read_b64_tr_b16 v[148:149], v21 offset:8192
    v_mfma_f32_16x16x32_bf16 v[208:211], v[164:167], v[116:119], v[208:211]
    ds_read_b64_tr_b16 v[150:151], v21 offset:8448
    v_mfma_f32_16x16x32_bf16 v[192:195], v[160:163], v[120:123], v[192:195]
    ds_read_b64_tr_b16 v[152:153], v20 offset:10240
    ds_read_b64_tr_b16 v[154:155], v20 offset:10496
    v_mfma_f32_16x16x32_bf16 v[212:215], v[164:167], v[120:123], v[212:215]
    ds_read_b64_tr_b16 v[156:157], v21 offset:10240
    ds_read_b64_tr_b16 v[158:159], v21 offset:10496
    v_mfma_f32_16x16x32_bf16 v[176:179], v[168:171], v[124:127], v[176:179]
    s_add_u32 m0, s69, 143360
    s_lshr_b32 s67, s66, 2
    s_xor_b32 s67, s67, 3
    s_lshl_b32 s67, s67, 8
    buffer_load_dwordx4 v58, s[12:15], s67 offen lds
    v_mfma_f32_16x16x32_bf16 v[196:199], v[172:175], v[124:127], v[196:199]
    s_add_u32 m0, s69, 147456
    s_add_u32 s67, s67, 16384
    buffer_load_dwordx4 v58, s[12:15], s67 offen lds
    v_mfma_f32_16x16x32_bf16 v[180:183], v[168:171], v[128:131], v[180:183]
    s_add_u32 m0, s69, 151552
    s_add_u32 s67, s67, 16384
    buffer_load_dwordx4 v58, s[12:15], s67 offen lds
    v_mfma_f32_16x16x32_bf16 v[200:203], v[172:175], v[128:131], v[200:203]
    s_add_u32 m0, s69, 155648
    s_add_u32 s67, s67, 16384
    buffer_load_dwordx4 v58, s[12:15], s67 offen lds
    v_mfma_f32_16x16x32_bf16 v[184:187], v[168:171], v[132:135], v[184:187]
    s_add_u32 m0, s69, 159744
    s_add_u32 s67, s67, 16384
    buffer_load_dwordx4 v58, s[12:15], s67 offen lds
    v_mfma_f32_16x16x32_bf16 v[204:207], v[172:175], v[132:135], v[204:207]
    v_mfma_f32_16x16x32_bf16 v[188:191], v[168:171], v[136:139], v[188:191]
    s_add_u32 m0, s68, 20480
    s_xor_b32 s33, s66, 10
    s_lshl_b32 s33, s33, 18
    buffer_load_dwordx4 v16, s[16:19], s33 offen offset:0 lds
    v_mfma_f32_16x16x32_bf16 v[208:211], v[172:175], v[136:139], v[208:211]
    buffer_load_dwordx4 v17, s[16:19], s33 offen offset:1024 lds
    v_mfma_f32_16x16x32_bf16 v[192:195], v[168:171], v[140:143], v[192:195]
    buffer_load_dwordx4 v18, s[16:19], s33 offen offset:2048 lds
    v_mfma_f32_16x16x32_bf16 v[212:215], v[172:175], v[140:143], v[212:215]
    buffer_load_dwordx4 v19, s[16:19], s33 offen offset:3072 lds
    s_waitcnt vmcnt(18)
    s_waitcnt lgkmcnt(0)
    v_mfma_f32_16x16x32_bf16 v[176:179], v[144:147], v[64:67], v[176:179]
    ds_read_b128 v[104:107], v28 offset:4096
    v_mfma_f32_16x16x32_bf16 v[196:199], v[148:151], v[64:67], v[196:199]
    ds_read_b128 v[108:111], v28 offset:36864
    ds_read_b128 v[112:115], v10 offset:4096
    v_mfma_f32_16x16x32_bf16 v[180:183], v[144:147], v[68:71], v[180:183]
    ds_read_b128 v[116:119], v10 offset:36864
    v_mfma_f32_16x16x32_bf16 v[200:203], v[148:151], v[68:71], v[200:203]
    ds_read_b128 v[120:123], v24 offset:4096
    v_mfma_f32_16x16x32_bf16 v[184:187], v[144:147], v[72:75], v[184:187]
    ds_read_b128 v[124:127], v29 offset:4096
    ds_read_b128 v[128:131], v29 offset:36864
    v_mfma_f32_16x16x32_bf16 v[204:207], v[148:151], v[72:75], v[204:207]
    ds_read_b128 v[132:135], v11 offset:4096
    v_mfma_f32_16x16x32_bf16 v[188:191], v[144:147], v[76:79], v[188:191]
    ds_read_b128 v[136:139], v11 offset:36864
    v_mfma_f32_16x16x32_bf16 v[208:211], v[148:151], v[76:79], v[208:211]
    ds_read_b128 v[140:143], v25 offset:4096
    v_mfma_f32_16x16x32_bf16 v[192:195], v[144:147], v[80:83], v[192:195]
    ds_read_b64_tr_b16 v[160:161], v20 offset:12288
    ds_read_b64_tr_b16 v[162:163], v20 offset:12544
    v_mfma_f32_16x16x32_bf16 v[212:215], v[148:151], v[80:83], v[212:215]
    ds_read_b64_tr_b16 v[164:165], v21 offset:12288
    v_mfma_f32_16x16x32_bf16 v[176:179], v[152:155], v[84:87], v[176:179]
    ds_read_b64_tr_b16 v[166:167], v21 offset:12544
    v_mfma_f32_16x16x32_bf16 v[196:199], v[156:159], v[84:87], v[196:199]
    ds_read_b64_tr_b16 v[168:169], v20 offset:14336
    ds_read_b64_tr_b16 v[170:171], v20 offset:14592
    v_mfma_f32_16x16x32_bf16 v[180:183], v[152:155], v[88:91], v[180:183]
    ds_read_b64_tr_b16 v[172:173], v21 offset:14336
    v_mfma_f32_16x16x32_bf16 v[200:203], v[156:159], v[88:91], v[200:203]
    ds_read_b64_tr_b16 v[174:175], v21 offset:14592
    v_mfma_f32_16x16x32_bf16 v[184:187], v[152:155], v[92:95], v[184:187]
    s_add_u32 m0, s68, 24576
    s_xor_b32 s33, s66, 12
    s_lshl_b32 s33, s33, 18
    buffer_load_dwordx4 v16, s[16:19], s33 offen offset:0 lds
    v_mfma_f32_16x16x32_bf16 v[204:207], v[156:159], v[92:95], v[204:207]
    v_mfma_f32_16x16x32_bf16 v[188:191], v[152:155], v[96:99], v[188:191]
    buffer_load_dwordx4 v17, s[16:19], s33 offen offset:1024 lds
    v_mfma_f32_16x16x32_bf16 v[208:211], v[156:159], v[96:99], v[208:211]
    buffer_load_dwordx4 v18, s[16:19], s33 offen offset:2048 lds
    v_mfma_f32_16x16x32_bf16 v[192:195], v[152:155], v[100:103], v[192:195]
    v_mfma_f32_16x16x32_bf16 v[212:215], v[156:159], v[100:103], v[212:215]
    buffer_load_dwordx4 v19, s[16:19], s33 offen offset:3072 lds
    s_waitcnt vmcnt(13)
    s_waitcnt lgkmcnt(0)
    s_barrier
    v_mfma_f32_16x16x32_bf16 v[176:179], v[160:163], v[104:107], v[176:179]
    ds_read_b128 v[64:67], v26 offset:8192
    v_mfma_f32_16x16x32_bf16 v[196:199], v[164:167], v[104:107], v[196:199]
    ds_read_b128 v[68:71], v26 offset:40960
    ds_read_b128 v[72:75], v8 offset:8192
    v_mfma_f32_16x16x32_bf16 v[180:183], v[160:163], v[108:111], v[180:183]
    ds_read_b128 v[76:79], v8 offset:40960
    v_mfma_f32_16x16x32_bf16 v[200:203], v[164:167], v[108:111], v[200:203]
    ds_read_b128 v[80:83], v22 offset:8192
    ds_read_b128 v[84:87], v27 offset:8192
    v_mfma_f32_16x16x32_bf16 v[184:187], v[160:163], v[112:115], v[184:187]
    ds_read_b128 v[88:91], v27 offset:40960
    v_mfma_f32_16x16x32_bf16 v[204:207], v[164:167], v[112:115], v[204:207]
    ds_read_b128 v[92:95], v9 offset:8192
    v_mfma_f32_16x16x32_bf16 v[188:191], v[160:163], v[116:119], v[188:191]
    ds_read_b128 v[96:99], v9 offset:40960
    ds_read_b128 v[100:103], v23 offset:8192
    v_mfma_f32_16x16x32_bf16 v[208:211], v[164:167], v[116:119], v[208:211]
    ds_read_b64_tr_b16 v[144:145], v20 offset:0
    v_mfma_f32_16x16x32_bf16 v[192:195], v[160:163], v[120:123], v[192:195]
    ds_read_b64_tr_b16 v[146:147], v20 offset:256
    ds_read_b64_tr_b16 v[148:149], v21 offset:0
    v_mfma_f32_16x16x32_bf16 v[212:215], v[164:167], v[120:123], v[212:215]
    ds_read_b64_tr_b16 v[150:151], v21 offset:256
    v_mfma_f32_16x16x32_bf16 v[176:179], v[168:171], v[124:127], v[176:179]
    ds_read_b64_tr_b16 v[152:153], v20 offset:2048
    v_mfma_f32_16x16x32_bf16 v[196:199], v[172:175], v[124:127], v[196:199]
    ds_read_b64_tr_b16 v[154:155], v20 offset:2304
    ds_read_b64_tr_b16 v[156:157], v21 offset:2048
    v_mfma_f32_16x16x32_bf16 v[180:183], v[168:171], v[128:131], v[180:183]
    ds_read_b64_tr_b16 v[158:159], v21 offset:2304
    v_mfma_f32_16x16x32_bf16 v[200:203], v[172:175], v[128:131], v[200:203]
    s_add_u32 m0, s68, 28672
    s_xor_b32 s33, s66, 14
    s_lshl_b32 s33, s33, 18
    buffer_load_dwordx4 v16, s[16:19], s33 offen offset:0 lds
    v_mfma_f32_16x16x32_bf16 v[184:187], v[168:171], v[132:135], v[184:187]
    buffer_load_dwordx4 v17, s[16:19], s33 offen offset:1024 lds
    v_mfma_f32_16x16x32_bf16 v[204:207], v[172:175], v[132:135], v[204:207]
    v_mfma_f32_16x16x32_bf16 v[188:191], v[168:171], v[136:139], v[188:191]
    buffer_load_dwordx4 v18, s[16:19], s33 offen offset:2048 lds
    v_mfma_f32_16x16x32_bf16 v[208:211], v[172:175], v[136:139], v[208:211]
    buffer_load_dwordx4 v19, s[16:19], s33 offen offset:3072 lds
    v_mfma_f32_16x16x32_bf16 v[192:195], v[168:171], v[140:143], v[192:195]
    v_mfma_f32_16x16x32_bf16 v[212:215], v[172:175], v[140:143], v[212:215]
    v_mov_b32 v1, 0
    buffer_load_dwordx2 v[34:35], v1, s[76:79], 0 offen sc0 sc1
    s_waitcnt vmcnt(9)
    s_waitcnt lgkmcnt(0)
    s_cmp_eq_u32 s64, 0
    s_cbranch_scc1 L_fa1
    s_add_u32 m0, s68, 0
    s_xor_b32 s30, s3, 0
    buffer_load_dwordx4 v40, s[4:7], s30 offen offset:0 nt lds
    buffer_load_dwordx4 v41, s[4:7], s30 offen offset:1024 nt lds
    buffer_load_dwordx4 v42, s[4:7], s30 offen offset:2048 nt lds
    buffer_load_dwordx4 v43, s[4:7], s30 offen offset:3072 nt lds
    s_branch L_fd2
L_fa1:
L_fd2:
    v_mfma_f32_16x16x32_bf16 v[176:179], v[144:147], v[64:67], v[176:179]
    ds_read_b128 v[104:107], v28 offset:8192
    v_mfma_f32_16x16x32_bf16 v[196:199], v[148:151], v[64:67], v[196:199]
    ds_read_b128 v[108:111], v28 offset:40960
    v_mfma_f32_16x16x32_bf16 v[180:183], v[144:147], v[68:71], v[180:183]
    ds_read_b128 v[112:115], v10 offset:8192
    v_mfma_f32_16x16x32_bf16 v[200:203], v[148:151], v[68:71], v[200:203]
    ds_read_b128 v[116:119], v10 offset:40960
    v_mfma_f32_16x16x32_bf16 v[184:187], v[144:147], v[72:75], v[184:187]
    ds_read_b128 v[120:123], v24 offset:8192
    v_mfma_f32_16x16x32_bf16 v[204:207], v[148:151], v[72:75], v[204:207]
    v_mfma_f32_16x16x32_bf16 v[188:191], v[144:147], v[76:79], v[188:191]
    ds_read_b128 v[124:127], v29 offset:8192
    v_mfma_f32_16x16x32_bf16 v[208:211], v[148:151], v[76:79], v[208:211]
    ds_read_b128 v[128:131], v29 offset:40960
    v_mfma_f32_16x16x32_bf16 v[192:195], v[144:147], v[80:83], v[192:195]
    ds_read_b128 v[132:135], v11 offset:8192
    v_mfma_f32_16x16x32_bf16 v[212:215], v[148:151], v[80:83], v[212:215]
    ds_read_b128 v[136:139], v11 offset:40960
    v_mfma_f32_16x16x32_bf16 v[176:179], v[152:155], v[84:87], v[176:179]
    ds_read_b128 v[140:143], v25 offset:8192
    v_mfma_f32_16x16x32_bf16 v[196:199], v[156:159], v[84:87], v[196:199]
    ds_read_b64_tr_b16 v[160:161], v20 offset:4096
    v_mfma_f32_16x16x32_bf16 v[180:183], v[152:155], v[88:91], v[180:183]
    ds_read_b64_tr_b16 v[162:163], v20 offset:4352
    v_mfma_f32_16x16x32_bf16 v[200:203], v[156:159], v[88:91], v[200:203]
    ds_read_b64_tr_b16 v[164:165], v21 offset:4096
    v_mfma_f32_16x16x32_bf16 v[184:187], v[152:155], v[92:95], v[184:187]
    ds_read_b64_tr_b16 v[166:167], v21 offset:4352
    v_mfma_f32_16x16x32_bf16 v[204:207], v[156:159], v[92:95], v[204:207]
    v_mfma_f32_16x16x32_bf16 v[188:191], v[152:155], v[96:99], v[188:191]
    ds_read_b64_tr_b16 v[168:169], v20 offset:6144
    v_mfma_f32_16x16x32_bf16 v[208:211], v[156:159], v[96:99], v[208:211]
    ds_read_b64_tr_b16 v[170:171], v20 offset:6400
    v_mfma_f32_16x16x32_bf16 v[192:195], v[152:155], v[100:103], v[192:195]
    ds_read_b64_tr_b16 v[172:173], v21 offset:6144
    v_mfma_f32_16x16x32_bf16 v[212:215], v[156:159], v[100:103], v[212:215]
    ds_read_b64_tr_b16 v[174:175], v21 offset:6400
    s_cmp_eq_u32 s64, 0
    s_cbranch_scc1 L_wa3
    s_waitcnt vmcnt(9)
    s_branch L_wb4
L_wa3:
    s_waitcnt vmcnt(5)
L_wb4:
    s_waitcnt lgkmcnt(0)
    s_barrier
    s_cmp_eq_u32 s64, 0
    s_cbranch_scc1 L_fa5
    s_add_u32 m0, s68, 4096
    s_xor_b32 s30, s3, 4096
    buffer_load_dwordx4 v40, s[4:7], s30 offen offset:0 nt lds
    buffer_load_dwordx4 v41, s[4:7], s30 offen offset:1024 nt lds
    buffer_load_dwordx4 v42, s[4:7], s30 offen offset:2048 nt lds
    buffer_load_dwordx4 v43, s[4:7], s30 offen offset:3072 nt lds
    s_branch L_fd6
L_fa5:
L_fd6:
    v_mfma_f32_16x16x32_bf16 v[176:179], v[160:163], v[104:107], v[176:179]
    ds_read_b128 v[64:67], v22 offset:12288
    v_mfma_f32_16x16x32_bf16 v[196:199], v[164:167], v[104:107], v[196:199]
    ds_read_b128 v[68:71], v22 offset:16384
    v_mfma_f32_16x16x32_bf16 v[180:183], v[160:163], v[108:111], v[180:183]
    ds_read_b128 v[72:75], v22 offset:20480
    v_mfma_f32_16x16x32_bf16 v[200:203], v[164:167], v[108:111], v[200:203]
    ds_read_b128 v[76:79], v22 offset:24576
    v_mfma_f32_16x16x32_bf16 v[184:187], v[160:163], v[112:115], v[184:187]
    ds_read_b128 v[80:83], v22 offset:28672
    v_mfma_f32_16x16x32_bf16 v[204:207], v[164:167], v[112:115], v[204:207]
    v_mfma_f32_16x16x32_bf16 v[188:191], v[160:163], v[116:119], v[188:191]
    ds_read_b128 v[84:87], v23 offset:12288
    v_mfma_f32_16x16x32_bf16 v[208:211], v[164:167], v[116:119], v[208:211]
    ds_read_b128 v[88:91], v23 offset:16384
    v_mfma_f32_16x16x32_bf16 v[192:195], v[160:163], v[120:123], v[192:195]
    ds_read_b128 v[92:95], v23 offset:20480
    v_mfma_f32_16x16x32_bf16 v[212:215], v[164:167], v[120:123], v[212:215]
    ds_read_b128 v[96:99], v23 offset:24576
    v_mfma_f32_16x16x32_bf16 v[176:179], v[168:171], v[124:127], v[176:179]
    ds_read_b128 v[100:103], v23 offset:28672
    v_mfma_f32_16x16x32_bf16 v[196:199], v[172:175], v[124:127], v[196:199]
    ds_read_b64_tr_b16 v[144:145], v20 offset:8192
    v_mfma_f32_16x16x32_bf16 v[180:183], v[168:171], v[128:131], v[180:183]
    ds_read_b64_tr_b16 v[146:147], v20 offset:8448
    v_mfma_f32_16x16x32_bf16 v[200:203], v[172:175], v[128:131], v[200:203]
    ds_read_b64_tr_b16 v[148:149], v21 offset:8192
    v_mfma_f32_16x16x32_bf16 v[184:187], v[168:171], v[132:135], v[184:187]
    ds_read_b64_tr_b16 v[150:151], v21 offset:8448
    v_mfma_f32_16x16x32_bf16 v[204:207], v[172:175], v[132:135], v[204:207]
    v_mfma_f32_16x16x32_bf16 v[188:191], v[168:171], v[136:139], v[188:191]
    ds_read_b64_tr_b16 v[152:153], v20 offset:10240
    v_mfma_f32_16x16x32_bf16 v[208:211], v[172:175], v[136:139], v[208:211]
    ds_read_b64_tr_b16 v[154:155], v20 offset:10496
    v_mfma_f32_16x16x32_bf16 v[192:195], v[168:171], v[140:143], v[192:195]
    ds_read_b64_tr_b16 v[156:157], v21 offset:10240
    v_mfma_f32_16x16x32_bf16 v[212:215], v[172:175], v[140:143], v[212:215]
    ds_read_b64_tr_b16 v[158:159], v21 offset:10496
    s_cmp_eq_u32 s64, 0
    s_cbranch_scc1 L_wa7
    s_waitcnt vmcnt(9)
    s_branch L_wb8
L_wa7:
    s_waitcnt vmcnt(1)
L_wb8:
    s_waitcnt lgkmcnt(0)
    s_cmp_eq_u32 s64, 0
    s_cbranch_scc1 L_fa9
    s_add_u32 m0, s68, 8192
    s_xor_b32 s30, s3, 0
    buffer_load_dwordx4 v44, s[8:11], s30 offen offset:0 nt lds
    buffer_load_dwordx4 v45, s[8:11], s30 offen offset:1024 nt lds
    buffer_load_dwordx4 v44, s[8:11], s30 offen offset:2048 nt lds
    buffer_load_dwordx4 v45, s[8:11], s30 offen offset:3072 nt lds
    s_branch L_fd10
L_fa9:
L_fd10:
    v_mfma_f32_16x16x32_bf16 v[176:179], v[144:147], v[64:67], v[176:179]
    ds_read_b128 v[104:107], v24 offset:12288
    v_mfma_f32_16x16x32_bf16 v[196:199], v[148:151], v[64:67], v[196:199]
    ds_read_b128 v[108:111], v24 offset:16384
    v_mfma_f32_16x16x32_bf16 v[180:183], v[144:147], v[68:71], v[180:183]
    ds_read_b128 v[112:115], v24 offset:20480
    v_mfma_f32_16x16x32_bf16 v[200:203], v[148:151], v[68:71], v[200:203]
    ds_read_b128 v[116:119], v24 offset:24576
    v_mfma_f32_16x16x32_bf16 v[184:187], v[144:147], v[72:75], v[184:187]
    ds_read_b128 v[120:123], v24 offset:28672
    v_mfma_f32_16x16x32_bf16 v[204:207], v[148:151], v[72:75], v[204:207]
    v_mfma_f32_16x16x32_bf16 v[188:191], v[144:147], v[76:79], v[188:191]
    ds_read_b128 v[124:127], v25 offset:12288
    v_mfma_f32_16x16x32_bf16 v[208:211], v[148:151], v[76:79], v[208:211]
    ds_read_b128 v[128:131], v25 offset:16384
    v_mfma_f32_16x16x32_bf16 v[192:195], v[144:147], v[80:83], v[192:195]
    ds_read_b128 v[132:135], v25 offset:20480
    v_mfma_f32_16x16x32_bf16 v[212:215], v[148:151], v[80:83], v[212:215]
    ds_read_b128 v[136:139], v25 offset:24576
    v_mfma_f32_16x16x32_bf16 v[176:179], v[152:155], v[84:87], v[176:179]
    ds_read_b128 v[140:143], v25 offset:28672
    v_mfma_f32_16x16x32_bf16 v[196:199], v[156:159], v[84:87], v[196:199]
    ds_read_b64_tr_b16 v[160:161], v20 offset:12288
    v_mfma_f32_16x16x32_bf16 v[180:183], v[152:155], v[88:91], v[180:183]
    ds_read_b64_tr_b16 v[162:163], v20 offset:12544
    v_mfma_f32_16x16x32_bf16 v[200:203], v[156:159], v[88:91], v[200:203]
    ds_read_b64_tr_b16 v[164:165], v21 offset:12288
    v_mfma_f32_16x16x32_bf16 v[184:187], v[152:155], v[92:95], v[184:187]
    ds_read_b64_tr_b16 v[166:167], v21 offset:12544
    v_mfma_f32_16x16x32_bf16 v[204:207], v[156:159], v[92:95], v[204:207]
    v_mfma_f32_16x16x32_bf16 v[188:191], v[152:155], v[96:99], v[188:191]
    ds_read_b64_tr_b16 v[168:169], v20 offset:14336
    v_mfma_f32_16x16x32_bf16 v[208:211], v[156:159], v[96:99], v[208:211]
    ds_read_b64_tr_b16 v[170:171], v20 offset:14592
    v_mfma_f32_16x16x32_bf16 v[192:195], v[152:155], v[100:103], v[192:195]
    ds_read_b64_tr_b16 v[172:173], v21 offset:14336
    v_mfma_f32_16x16x32_bf16 v[212:215], v[156:159], v[100:103], v[212:215]
    ds_read_b64_tr_b16 v[174:175], v21 offset:14592
    s_waitcnt lgkmcnt(0)
    s_barrier
    s_cmp_eq_u32 s64, 0
    s_cbranch_scc1 L_fa11
    s_add_u32 m0, s68, 12288
    s_xor_b32 s30, s3, 4096
    buffer_load_dwordx4 v44, s[8:11], s30 offen offset:0 nt lds
    buffer_load_dwordx4 v45, s[8:11], s30 offen offset:1024 nt lds
    buffer_load_dwordx4 v44, s[8:11], s30 offen offset:2048 nt lds
    buffer_load_dwordx4 v45, s[8:11], s30 offen offset:3072 nt lds
    s_branch L_fd12
L_fa11:
L_fd12:
    v_mfma_f32_16x16x32_bf16 v[176:179], v[160:163], v[104:107], v[176:179]
    v_mfma_f32_16x16x32_bf16 v[196:199], v[164:167], v[104:107], v[196:199]
    v_mfma_f32_16x16x32_bf16 v[180:183], v[160:163], v[108:111], v[180:183]
    v_mfma_f32_16x16x32_bf16 v[200:203], v[164:167], v[108:111], v[200:203]
    v_mfma_f32_16x16x32_bf16 v[184:187], v[160:163], v[112:115], v[184:187]
    v_mfma_f32_16x16x32_bf16 v[204:207], v[164:167], v[112:115], v[204:207]
    v_mfma_f32_16x16x32_bf16 v[188:191], v[160:163], v[116:119], v[188:191]
    v_mfma_f32_16x16x32_bf16 v[208:211], v[164:167], v[116:119], v[208:211]
    v_mfma_f32_16x16x32_bf16 v[192:195], v[160:163], v[120:123], v[192:195]
    v_mfma_f32_16x16x32_bf16 v[212:215], v[164:167], v[120:123], v[212:215]
    v_mfma_f32_16x16x32_bf16 v[176:179], v[168:171], v[124:127], v[176:179]
    v_mfma_f32_16x16x32_bf16 v[196:199], v[172:175], v[124:127], v[196:199]
    v_mfma_f32_16x16x32_bf16 v[180:183], v[168:171], v[128:131], v[180:183]
    v_mfma_f32_16x16x32_bf16 v[200:203], v[172:175], v[128:131], v[200:203]
    v_mfma_f32_16x16x32_bf16 v[184:187], v[168:171], v[132:135], v[184:187]
    v_mfma_f32_16x16x32_bf16 v[204:207], v[172:175], v[132:135], v[204:207]
    v_mfma_f32_16x16x32_bf16 v[188:191], v[168:171], v[136:139], v[188:191]
    v_mfma_f32_16x16x32_bf16 v[208:211], v[172:175], v[136:139], v[208:211]
    v_mfma_f32_16x16x32_bf16 v[192:195], v[168:171], v[140:143], v[192:195]
    v_mfma_f32_16x16x32_bf16 v[212:215], v[172:175], v[140:143], v[212:215]
    s_nop 7
    s_mul_i32 s29, s24, 5120
    s_cmp_eq_u32 s64, 0
    s_cbranch_scc1 L_Apath
    s_add_u32 s29, s29, 131072
    v_add_u32 v38, s29, v30
    v_pk_mul_f32 v[176:177], v[176:177], v[6:7]
    v_pk_mul_f32 v[178:179], v[178:179], v[6:7]
    v_cvt_pk_bf16_f32 v8, v176, v177
    v_cvt_pk_bf16_f32 v9, v178, v179
    ds_write_b64 v38, v[8:9] offset:0
    v_pk_mul_f32 v[196:197], v[196:197], v[6:7]
    v_pk_mul_f32 v[198:199], v[198:199], v[6:7]
    v_cvt_pk_bf16_f32 v10, v196, v197
    v_cvt_pk_bf16_f32 v11, v198, v199
    ds_write_b64 v38, v[10:11] offset:512
    v_pk_mul_f32 v[180:181], v[180:181], v[6:7]
    v_pk_mul_f32 v[182:183], v[182:183], v[6:7]
    v_cvt_pk_bf16_f32 v8, v180, v181
    v_cvt_pk_bf16_f32 v9, v182, v183
    ds_write_b64 v38, v[8:9] offset:1024
    v_pk_mul_f32 v[200:201], v[200:201], v[6:7]
    v_pk_mul_f32 v[202:203], v[202:203], v[6:7]
    v_cvt_pk_bf16_f32 v10, v200, v201
    v_cvt_pk_bf16_f32 v11, v202, v203
    ds_write_b64 v38, v[10:11] offset:1536
    v_pk_mul_f32 v[184:185], v[184:185], v[6:7]
    v_pk_mul_f32 v[186:187], v[186:187], v[6:7]
    v_cvt_pk_bf16_f32 v8, v184, v185
    v_cvt_pk_bf16_f32 v9, v186, v187
    ds_write_b64 v38, v[8:9] offset:2048
    v_pk_mul_f32 v[204:205], v[204:205], v[6:7]
    v_pk_mul_f32 v[206:207], v[206:207], v[6:7]
    v_cvt_pk_bf16_f32 v10, v204, v205
    v_cvt_pk_bf16_f32 v11, v206, v207
    ds_write_b64 v38, v[10:11] offset:2560
    v_pk_mul_f32 v[188:189], v[188:189], v[6:7]
    v_pk_mul_f32 v[190:191], v[190:191], v[6:7]
    v_cvt_pk_bf16_f32 v8, v188, v189
    v_cvt_pk_bf16_f32 v9, v190, v191
    ds_write_b64 v38, v[8:9] offset:3072
    v_pk_mul_f32 v[208:209], v[208:209], v[6:7]
    v_pk_mul_f32 v[210:211], v[210:211], v[6:7]
    v_cvt_pk_bf16_f32 v10, v208, v209
    v_cvt_pk_bf16_f32 v11, v210, v211
    ds_write_b64 v38, v[10:11] offset:3584
    v_pk_mul_f32 v[192:193], v[192:193], v[6:7]
    v_pk_mul_f32 v[194:195], v[194:195], v[6:7]
    v_cvt_pk_bf16_f32 v8, v192, v193
    v_cvt_pk_bf16_f32 v9, v194, v195
    ds_write_b64 v38, v[8:9] offset:4096
    v_pk_mul_f32 v[212:213], v[212:213], v[6:7]
    v_pk_mul_f32 v[214:215], v[214:215], v[6:7]
    v_cvt_pk_bf16_f32 v10, v212, v213
    v_cvt_pk_bf16_f32 v11, v214, v215
    ds_write_b64 v38, v[10:11] offset:4608
    v_mov_b32 v236, 0
    v_mov_b32 v237, 0
    v_mov_b32 v238, 0
    v_mov_b32 v239, 0
    v_mov_b32 v240, 0
    v_mov_b32 v241, 0
    v_mov_b32 v242, 0
    v_mov_b32 v243, 0
    v_mov_b32 v244, 0
    v_mov_b32 v245, 0
    v_mov_b32 v246, 0
    v_mov_b32 v247, 0
    v_mov_b32 v248, 0
    v_mov_b32 v249, 0
    v_mov_b32 v250, 0
    v_mov_b32 v251, 0
    v_mov_b32 v252, 0
    v_mov_b32 v253, 0
    v_mov_b32 v254, 0
    v_mov_b32 v255, 0
    v_mov_b32 v160, 0
    v_mov_b32 v161, 0
    v_mov_b32 v162, 0
    v_mov_b32 v163, 0
    v_mov_b32 v164, 0
    v_mov_b32 v165, 0
    v_mov_b32 v166, 0
    v_mov_b32 v167, 0
    v_mov_b32 v168, 0
    v_mov_b32 v169, 0
    v_mov_b32 v170, 0
    v_mov_b32 v171, 0
    v_mov_b32 v172, 0
    v_mov_b32 v173, 0
    v_mov_b32 v174, 0
    v_mov_b32 v175, 0
    v_mov_b32 v176, 0
    v_mov_b32 v177, 0
    v_mov_b32 v178, 0
    v_mov_b32 v179, 0
    v_mov_b32 v180, 0
    v_mov_b32 v181, 0
    v_mov_b32 v182, 0
    v_mov_b32 v183, 0
    v_mov_b32 v184, 0
    v_mov_b32 v185, 0
    v_mov_b32 v186, 0
    v_mov_b32 v187, 0
    v_mov_b32 v188, 0
    v_mov_b32 v189, 0
    v_mov_b32 v190, 0
    v_mov_b32 v191, 0
    v_mov_b32 v212, 0
    v_mov_b32 v213, 0
    v_mov_b32 v214, 0
    v_mov_b32 v215, 0
    s_waitcnt lgkmcnt(0)
    s_barrier
    s_cmp_eq_u32 s65, 1
    s_cbranch_scc1 L_t0
    v_add_u32 v38, 131072, v33
    ds_read_b128 a[160:163], v38 offset:0
    ds_read_b128 a[176:179], v38 offset:1024
    ds_read_b128 a[192:195], v38 offset:2048
    ds_read_b128 a[208:211], v38 offset:3072
    ds_read_b128 a[224:227], v38 offset:4096
    ds_read_b128 a[164:167], v38 offset:5120
    ds_read_b128 a[180:183], v38 offset:6144
    ds_read_b128 a[196:199], v38 offset:7168
    ds_read_b128 a[212:215], v38 offset:8192
    ds_read_b128 a[228:231], v38 offset:9216
    ds_read_b128 a[168:171], v38 offset:10240
    ds_read_b128 a[184:187], v38 offset:11264
    ds_read_b128 a[200:203], v38 offset:12288
    ds_read_b128 a[216:219], v38 offset:13312
    ds_read_b128 a[232:235], v38 offset:14336
    ds_read_b128 a[172:175], v38 offset:15360
    ds_read_b128 a[188:191], v38 offset:16384
    ds_read_b128 a[204:207], v38 offset:17408
    ds_read_b128 a[220:223], v38 offset:18432
    ds_read_b128 a[236:239], v38 offset:19456
L_t0:
    s_waitcnt vmcnt(0)
    ds_read_b128 v[64:67], v46 offset:0
    ds_read_b128 v[68:71], v47 offset:0
    ds_read_b128 v[72:75], v48 offset:0
    ds_read_b128 v[76:79], v49 offset:0
    ds_read_b128 v[80:83], v46 offset:4096
    ds_read_b128 v[84:87], v47 offset:4096
    ds_read_b128 v[88:91], v48 offset:4096
    ds_read_b128 v[92:95], v49 offset:4096
    ds_read_b64_tr_b16 v[128:129], v50 offset:8192
    ds_read_b64_tr_b16 v[132:133], v51 offset:8192
    ds_read_b64_tr_b16 v[136:137], v52 offset:8192
    ds_read_b64_tr_b16 v[140:141], v53 offset:8192
    ds_read_b64_tr_b16 v[144:145], v54 offset:8192
    ds_read_b64_tr_b16 v[148:149], v55 offset:8192
    ds_read_b64_tr_b16 v[152:153], v56 offset:8192
    ds_read_b64_tr_b16 v[156:157], v57 offset:8192
    ds_read_b64_tr_b16 v[130:131], v50 offset:12288
    ds_read_b64_tr_b16 v[134:135], v51 offset:12288
    ds_read_b64_tr_b16 v[138:139], v52 offset:12288
    ds_read_b64_tr_b16 v[142:143], v53 offset:12288
    ds_read_b64_tr_b16 v[146:147], v54 offset:12288
    ds_read_b64_tr_b16 v[150:151], v55 offset:12288
    ds_read_b64_tr_b16 v[154:155], v56 offset:12288
    ds_read_b64_tr_b16 v[158:159], v57 offset:12288
    s_waitcnt lgkmcnt(0)
    s_add_u32 m0, s68, 0
    s_xor_b32 s30, s3, 8192
    buffer_load_dwordx4 v40, s[4:7], s30 offen offset:0 nt lds
    buffer_load_dwordx4 v41, s[4:7], s30 offen offset:1024 nt lds
    buffer_load_dwordx4 v42, s[4:7], s30 offen offset:2048 nt lds
    buffer_load_dwordx4 v43, s[4:7], s30 offen offset:3072 nt lds
    s_add_u32 m0, s68, 4096
    s_xor_b32 s30, s3, 12288
    buffer_load_dwordx4 v40, s[4:7], s30 offen offset:0 nt lds
    buffer_load_dwordx4 v41, s[4:7], s30 offen offset:1024 nt lds
    buffer_load_dwordx4 v42, s[4:7], s30 offen offset:2048 nt lds
    buffer_load_dwordx4 v43, s[4:7], s30 offen offset:3072 nt lds
    s_add_u32 m0, s68, 8192
    s_xor_b32 s30, s3, 8192
    buffer_load_dwordx4 v44, s[8:11], s30 offen offset:0 nt lds
    buffer_load_dwordx4 v45, s[8:11], s30 offen offset:1024 nt lds
    buffer_load_dwordx4 v44, s[8:11], s30 offen offset:2048 nt lds
    buffer_load_dwordx4 v45, s[8:11], s30 offen offset:3072 nt lds
    s_add_u32 m0, s68, 12288
    s_xor_b32 s30, s3, 12288
    buffer_load_dwordx4 v44, s[8:11], s30 offen offset:0 nt lds
    buffer_load_dwordx4 v45, s[8:11], s30 offen offset:1024 nt lds
    buffer_load_dwordx4 v44, s[8:11], s30 offen offset:2048 nt lds
    buffer_load_dwordx4 v45, s[8:11], s30 offen offset:3072 nt lds
    s_cmp_eq_u32 s65, 0
    s_cbranch_scc1 L_mref
    s_mov_b32 s75, 400000
L_tag13:
    v_readfirstlane_b32 s29, v34
    s_nop 3
    s_cmp_lg_u32 s29, 0
    s_cbranch_scc1 L_tagd14
    s_sub_u32 s75, s75, 1
    s_cbranch_scc1 L_tagd14
    s_sleep 1
    v_mov_b32 v1, 0
    buffer_load_dwordx2 v[34:35], v1, s[76:79], 0 offen sc0 sc1
    s_waitcnt vmcnt(0)
    s_branch L_tag13
L_tagd14:
    v_and_b32 v1, 3, v0
    v_lshlrev_b32 v1, 3, v1
    s_mov_b32 s75, 400000
L_qp15:
    buffer_load_dwordx2 v[2:3], v1, s[80:83], s96 offen sc0 sc1
    s_waitcnt vmcnt(0)
    v_cmp_ne_u64 vcc, v[2:3], v[34:35]
    s_nop 4
    s_cbranch_vccz L_qpd16
    s_sub_u32 s75, s75, 1
    s_cbranch_scc1 L_qpd16
    s_sleep 1
    s_branch L_qp15
L_qpd16:
    s_mov_b32 s30, 0
    buffer_load_dwordx4 a[160:163], v33, s[20:23], s30 offen offset:0 sc0 sc1
    buffer_load_dwordx4 a[176:179], v33, s[20:23], s30 offen offset:1024 sc0 sc1
    buffer_load_dwordx4 a[192:195], v33, s[20:23], s30 offen offset:2048 sc0 sc1
    buffer_load_dwordx4 a[208:211], v33, s[20:23], s30 offen offset:3072 sc0 sc1
    s_mov_b32 s30, 4096
    buffer_load_dwordx4 a[224:227], v33, s[20:23], s30 offen offset:0 sc0 sc1
    buffer_load_dwordx4 a[164:167], v33, s[20:23], s30 offen offset:1024 sc0 sc1
    buffer_load_dwordx4 a[180:183], v33, s[20:23], s30 offen offset:2048 sc0 sc1
    buffer_load_dwordx4 a[196:199], v33, s[20:23], s30 offen offset:3072 sc0 sc1
    s_mov_b32 s30, 8192
    buffer_load_dwordx4 a[212:215], v33, s[20:23], s30 offen offset:0 sc0 sc1
    buffer_load_dwordx4 a[228:231], v33, s[20:23], s30 offen offset:1024 sc0 sc1
    buffer_load_dwordx4 a[168:171], v33, s[20:23], s30 offen offset:2048 sc0 sc1
    buffer_load_dwordx4 a[184:187], v33, s[20:23], s30 offen offset:3072 sc0 sc1
    s_mov_b32 s30, 12288
    buffer_load_dwordx4 a[200:203], v33, s[20:23], s30 offen offset:0 sc0 sc1
    buffer_load_dwordx4 a[216:219], v33, s[20:23], s30 offen offset:1024 sc0 sc1
    buffer_load_dwordx4 a[232:235], v33, s[20:23], s30 offen offset:2048 sc0 sc1
    buffer_load_dwordx4 a[172:175], v33, s[20:23], s30 offen offset:3072 sc0 sc1
    s_mov_b32 s30, 16384
    buffer_load_dwordx4 a[188:191], v33, s[20:23], s30 offen offset:0 sc0 sc1
    buffer_load_dwordx4 a[204:207], v33, s[20:23], s30 offen offset:1024 sc0 sc1
    buffer_load_dwordx4 a[220:223], v33, s[20:23], s30 offen offset:2048 sc0 sc1
    buffer_load_dwordx4 a[236:239], v33, s[20:23], s30 offen offset:3072 sc0 sc1
    s_waitcnt vmcnt(0)
    s_branch L_mref
L_Apath:
    v_add_u32 v38, s29, v30
    v_pk_mul_f32 v[176:177], v[176:177], v[6:7]
    v_pk_mul_f32 v[178:179], v[178:179], v[6:7]
    v_cvt_pk_bf16_f32 v216, v176, v177
    v_cvt_pk_bf16_f32 v217, v178, v179
    s_mov_b32 s30, 0
    buffer_store_dwordx2 v[216:217], v38, s[20:23], s30 offen offset:0 sc0 sc1
    v_pk_mul_f32 v[196:197], v[196:197], v[6:7]
    v_pk_mul_f32 v[198:199], v[198:199], v[6:7]
    v_cvt_pk_bf16_f32 v218, v196, v197
    v_cvt_pk_bf16_f32 v219, v198, v199
    buffer_store_dwordx2 v[218:219], v38, s[20:23], s30 offen offset:512 sc0 sc1
    v_pk_mul_f32 v[180:181], v[180:181], v[6:7]
    v_pk_mul_f32 v[182:183], v[182:183], v[6:7]
    v_cvt_pk_bf16_f32 v220, v180, v181
    v_cvt_pk_bf16_f32 v221, v182, v183
    buffer_store_dwordx2 v[220:221], v38, s[20:23], s30 offen offset:1024 sc0 sc1
    v_pk_mul_f32 v[200:201], v[200:201], v[6:7]
    v_pk_mul_f32 v[202:203], v[202:203], v[6:7]
    v_cvt_pk_bf16_f32 v222, v200, v201
    v_cvt_pk_bf16_f32 v223, v202, v203
    buffer_store_dwordx2 v[222:223], v38, s[20:23], s30 offen offset:1536 sc0 sc1
    v_pk_mul_f32 v[184:185], v[184:185], v[6:7]
    v_pk_mul_f32 v[186:187], v[186:187], v[6:7]
    v_cvt_pk_bf16_f32 v224, v184, v185
    v_cvt_pk_bf16_f32 v225, v186, v187
    buffer_store_dwordx2 v[224:225], v38, s[20:23], s30 offen offset:2048 sc0 sc1
    v_pk_mul_f32 v[204:205], v[204:205], v[6:7]
    v_pk_mul_f32 v[206:207], v[206:207], v[6:7]
    v_cvt_pk_bf16_f32 v226, v204, v205
    v_cvt_pk_bf16_f32 v227, v206, v207
    buffer_store_dwordx2 v[226:227], v38, s[20:23], s30 offen offset:2560 sc0 sc1
    v_pk_mul_f32 v[188:189], v[188:189], v[6:7]
    v_pk_mul_f32 v[190:191], v[190:191], v[6:7]
    v_cvt_pk_bf16_f32 v228, v188, v189
    v_cvt_pk_bf16_f32 v229, v190, v191
    buffer_store_dwordx2 v[228:229], v38, s[20:23], s30 offen offset:3072 sc0 sc1
    v_pk_mul_f32 v[208:209], v[208:209], v[6:7]
    v_pk_mul_f32 v[210:211], v[210:211], v[6:7]
    v_cvt_pk_bf16_f32 v230, v208, v209
    v_cvt_pk_bf16_f32 v231, v210, v211
    buffer_store_dwordx2 v[230:231], v38, s[20:23], s30 offen offset:3584 sc0 sc1
    v_pk_mul_f32 v[192:193], v[192:193], v[6:7]
    v_pk_mul_f32 v[194:195], v[194:195], v[6:7]
    v_cvt_pk_bf16_f32 v232, v192, v193
    v_cvt_pk_bf16_f32 v233, v194, v195
    s_mov_b32 s30, 4096
    buffer_store_dwordx2 v[232:233], v38, s[20:23], s30 offen offset:0 sc0 sc1
    v_pk_mul_f32 v[212:213], v[212:213], v[6:7]
    v_pk_mul_f32 v[214:215], v[214:215], v[6:7]
    v_cvt_pk_bf16_f32 v234, v212, v213
    v_cvt_pk_bf16_f32 v235, v214, v215
    buffer_store_dwordx2 v[234:235], v38, s[20:23], s30 offen offset:512 sc0 sc1
    s_add_u32 m0, s69, 0
    s_lshr_b32 s67, s66, 2
    s_xor_b32 s67, s67, 0
    s_lshl_b32 s67, s67, 8
    buffer_load_dwordx4 v58, s[88:91], s67 offen lds
    s_add_u32 m0, s69, 32768
    s_add_u32 s67, s67, 16384
    buffer_load_dwordx4 v58, s[88:91], s67 offen lds
    s_add_u32 m0, s69, 65536
    s_add_u32 s67, s67, 16384
    buffer_load_dwordx4 v58, s[88:91], s67 offen lds
    s_add_u32 m0, s69, 98304
    s_add_u32 s67, s67, 16384
    buffer_load_dwordx4 v58, s[88:91], s67 offen lds
    s_add_u32 m0, s69, 131072
    s_add_u32 s67, s67, 16384
    buffer_load_dwordx4 v58, s[88:91], s67 offen lds
    v_lshrrev_b32 v1, 4, v0
    v_and_b32 v2, 15, v0
    v_lshrrev_b32 v5, 2, v2
    v_lshl_add_u32 v3, v1, 3, v5
    v_and_b32 v5, 2, v5
    v_and_b32 v4, 1, v1
    v_lshl_or_b32 v5, v4, 2, v5
    v_bfe_u32 v4, v2, 1, 1
    v_xor_b32 v5, v5, v4
    v_lshlrev_b32 v5, 4, v5
    v_lshl_add_u32 v5, v3, 7, v5
    v_and_b32 v4, 1, v2
    v_lshl_add_u32 v5, v4, 3, v5
    v_add_u32 v5, s68, v5
    v_add_u32 v5, 16384, v5
    v_xor_b32 v160, 0, v5
    v_xor_b32 v161, 32, v5
    v_xor_b32 v162, 64, v5
    v_xor_b32 v163, 96, v5
    s_waitcnt vmcnt(5)
    s_mov_b32 s75, 400000
L_tag17:
    v_readfirstlane_b32 s29, v34
    s_nop 3
    s_cmp_lg_u32 s29, 0
    s_cbranch_scc1 L_tagd18
    s_sub_u32 s75, s75, 1
    s_cbranch_scc1 L_tagd18
    s_sleep 1
    v_mov_b32 v1, 0
    buffer_load_dwordx2 v[34:35], v1, s[76:79], 0 offen sc0 sc1
    s_waitcnt vmcnt(0)
    s_branch L_tag17
L_tagd18:
    s_lshl_b32 s30, s24, 3
    s_add_u32 s30, s30, s96
    v_mov_b32 v1, 0
    s_mov_b64 exec, 1
    buffer_store_dwordx2 v[34:35], v1, s[80:83], s30 offen sc0 sc1
    s_mov_b64 exec, -1
    s_add_u32 m0, s68, 16384
    s_xor_b32 s33, s66, 0
    s_lshl_b32 s33, s33, 18
    buffer_load_dwordx4 v12, s[92:95], s33 offen offset:0 lds
    buffer_load_dwordx4 v13, s[92:95], s33 offen offset:1024 lds
    buffer_load_dwordx4 v14, s[92:95], s33 offen offset:2048 lds
    buffer_load_dwordx4 v15, s[92:95], s33 offen offset:3072 lds
    s_add_u32 m0, s68, 20480
    s_xor_b32 s33, s66, 1
    s_lshl_b32 s33, s33, 18
    buffer_load_dwordx4 v12, s[92:95], s33 offen offset:0 lds
    buffer_load_dwordx4 v13, s[92:95], s33 offen offset:1024 lds
    buffer_load_dwordx4 v14, s[92:95], s33 offen offset:2048 lds
    buffer_load_dwordx4 v15, s[92:95], s33 offen offset:3072 lds
    s_waitcnt vmcnt(4)
    s_barrier
    ds_read_b128 v[64:67], v26 offset:0
    ds_read_b128 v[68:71], v26 offset:32768
    ds_read_b128 v[72:75], v8 offset:0
    ds_read_b128 v[76:79], v8 offset:32768
    ds_read_b128 v[80:83], v22 offset:0
    ds_read_b64_tr_b16 v[104:105], v160 offset:0
    ds_read_b64_tr_b16 v[106:107], v160 offset:512
    ds_read_b64_tr_b16 v[108:109], v161 offset:0
    ds_read_b64_tr_b16 v[110:111], v161 offset:512
    ds_read_b64_tr_b16 v[112:113], v162 offset:0
    ds_read_b64_tr_b16 v[114:115], v162 offset:512
    ds_read_b64_tr_b16 v[116:117], v163 offset:0
    ds_read_b64_tr_b16 v[118:119], v163 offset:512
    s_waitcnt vmcnt(0)
    s_waitcnt lgkmcnt(0)
    v_mfma_f32_16x16x32_bf16 v[176:179], v[104:107], v[64:67], 0
    ds_read_b128 v[84:87], v27 offset:0
    v_mfma_f32_16x16x32_bf16 v[196:199], v[108:111], v[64:67], 0
    ds_read_b128 v[88:91], v27 offset:32768
    ds_read_b128 v[92:95], v9 offset:0
    v_mfma_f32_16x16x32_bf16 v[216:219], v[112:115], v[64:67], 0
    ds_read_b128 v[96:99], v9 offset:32768
    v_mfma_f32_16x16x32_bf16 v[236:239], v[116:119], v[64:67], 0
    ds_read_b128 v[100:103], v23 offset:0
    ds_read_b64_tr_b16 v[120:121], v160 offset:4096
    v_mfma_f32_16x16x32_bf16 v[180:183], v[104:107], v[68:71], 0
    ds_read_b64_tr_b16 v[122:123], v160 offset:4608
    v_mfma_f32_16x16x32_bf16 v[200:203], v[108:111], v[68:71], 0
    ds_read_b64_tr_b16 v[124:125], v161 offset:4096
    ds_read_b64_tr_b16 v[126:127], v161 offset:4608
    v_mfma_f32_16x16x32_bf16 v[220:223], v[112:115], v[68:71], 0
    ds_read_b64_tr_b16 v[128:129], v162 offset:4096
    v_mfma_f32_16x16x32_bf16 v[240:243], v[116:119], v[68:71], 0
    ds_read_b64_tr_b16 v[130:131], v162 offset:4608
    ds_read_b64_tr_b16 v[132:133], v163 offset:4096
    v_mfma_f32_16x16x32_bf16 v[184:187], v[104:107], v[72:75], 0
    ds_read_b64_tr_b16 v[134:135], v163 offset:4608
    v_mfma_f32_16x16x32_bf16 v[204:207], v[108:111], v[72:75], 0
    s_add_u32 m0, s68, 24576
    s_xor_b32 s33, s66, 2
    s_lshl_b32 s33, s33, 18
    buffer_load_dwordx4 v12, s[92:95], s33 offen offset:0 lds
    v_mfma_f32_16x16x32_bf16 v[224:227], v[112:115], v[72:75], 0
    v_mfma_f32_16x16x32_bf16 v[244:247], v[116:119], v[72:75], 0
    buffer_load_dwordx4 v13, s[92:95], s33 offen offset:1024 lds
    v_mfma_f32_16x16x32_bf16 v[188:191], v[104:107], v[76:79], 0
    buffer_load_dwordx4 v14, s[92:95], s33 offen offset:2048 lds
    v_mfma_f32_16x16x32_bf16 v[208:211], v[108:111], v[76:79], 0
    buffer_load_dwordx4 v15, s[92:95], s33 offen offset:3072 lds
    v_mfma_f32_16x16x32_bf16 v[228:231], v[112:115], v[76:79], 0
    v_mfma_f32_16x16x32_bf16 v[248:251], v[116:119], v[76:79], 0
    s_add_u32 m0, s68, 28672
    s_xor_b32 s33, s66, 3
    s_lshl_b32 s33, s33, 18
    buffer_load_dwordx4 v12, s[92:95], s33 offen offset:0 lds
    v_mfma_f32_16x16x32_bf16 v[192:195], v[104:107], v[80:83], 0
    buffer_load_dwordx4 v13, s[92:95], s33 offen offset:1024 lds
    v_mfma_f32_16x16x32_bf16 v[212:215], v[108:111], v[80:83], 0
    buffer_load_dwordx4 v14, s[92:95], s33 offen offset:2048 lds
    v_mfma_f32_16x16x32_bf16 v[232:235], v[112:115], v[80:83], 0
    v_mfma_f32_16x16x32_bf16 v[252:255], v[116:119], v[80:83], 0
    buffer_load_dwordx4 v15, s[92:95], s33 offen offset:3072 lds
    s_waitcnt vmcnt(4)
    s_waitcnt lgkmcnt(0)
    v_mfma_f32_16x16x32_bf16 v[176:179], v[120:123], v[84:87], v[176:179]
    ds_read_b128 v[64:67], v28 offset:0
    ds_read_b128 v[68:71], v28 offset:32768
    v_mfma_f32_16x16x32_bf16 v[196:199], v[124:127], v[84:87], v[196:199]
    ds_read_b128 v[72:75], v10 offset:0
    v_mfma_f32_16x16x32_bf16 v[216:219], v[128:131], v[84:87], v[216:219]
    ds_read_b128 v[76:79], v10 offset:32768
    ds_read_b128 v[80:83], v24 offset:0
    v_mfma_f32_16x16x32_bf16 v[236:239], v[132:135], v[84:87], v[236:239]
    ds_read_b64_tr_b16 v[104:105], v160 offset:8192
    v_mfma_f32_16x16x32_bf16 v[180:183], v[120:123], v[88:91], v[180:183]
    ds_read_b64_tr_b16 v[106:107], v160 offset:8704
    ds_read_b64_tr_b16 v[108:109], v161 offset:8192
    v_mfma_f32_16x16x32_bf16 v[200:203], v[124:127], v[88:91], v[200:203]
    ds_read_b64_tr_b16 v[110:111], v161 offset:8704
    v_mfma_f32_16x16x32_bf16 v[220:223], v[128:131], v[88:91], v[220:223]
    ds_read_b64_tr_b16 v[112:113], v162 offset:8192
    ds_read_b64_tr_b16 v[114:115], v162 offset:8704
    v_mfma_f32_16x16x32_bf16 v[240:243], v[132:135], v[88:91], v[240:243]
    ds_read_b64_tr_b16 v[116:117], v163 offset:8192
    v_mfma_f32_16x16x32_bf16 v[184:187], v[120:123], v[92:95], v[184:187]
    ds_read_b64_tr_b16 v[118:119], v163 offset:8704
    v_mfma_f32_16x16x32_bf16 v[204:207], v[124:127], v[92:95], v[204:207]
    s_add_u32 m0, s69, 4096
    s_lshr_b32 s67, s66, 2
    s_xor_b32 s67, s67, 1
    s_lshl_b32 s67, s67, 8
    buffer_load_dwordx4 v58, s[88:91], s67 offen lds
    v_mfma_f32_16x16x32_bf16 v[224:227], v[128:131], v[92:95], v[224:227]
    s_add_u32 m0, s69, 36864
    s_add_u32 s67, s67, 16384
    buffer_load_dwordx4 v58, s[88:91], s67 offen lds
    v_mfma_f32_16x16x32_bf16 v[244:247], v[132:135], v[92:95], v[244:247]
    s_add_u32 m0, s69, 69632
    s_add_u32 s67, s67, 16384
    buffer_load_dwordx4 v58, s[88:91], s67 offen lds
    v_mfma_f32_16x16x32_bf16 v[188:191], v[120:123], v[96:99], v[188:191]
    s_add_u32 m0, s69, 102400
    s_add_u32 s67, s67, 16384
    buffer_load_dwordx4 v58, s[88:91], s67 offen lds
    v_mfma_f32_16x16x32_bf16 v[208:211], v[124:127], v[96:99], v[208:211]
    v_mfma_f32_16x16x32_bf16 v[228:231], v[128:131], v[96:99], v[228:231]
    s_add_u32 m0, s69, 135168
    s_add_u32 s67, s67, 16384
    buffer_load_dwordx4 v58, s[88:91], s67 offen lds
    v_mfma_f32_16x16x32_bf16 v[248:251], v[132:135], v[96:99], v[248:251]
    s_add_u32 m0, s68, 16384
    s_xor_b32 s33, s66, 4
    s_lshl_b32 s33, s33, 18
    buffer_load_dwordx4 v12, s[92:95], s33 offen offset:0 lds
    v_mfma_f32_16x16x32_bf16 v[192:195], v[120:123], v[100:103], v[192:195]
    buffer_load_dwordx4 v13, s[92:95], s33 offen offset:1024 lds
    v_mfma_f32_16x16x32_bf16 v[212:215], v[124:127], v[100:103], v[212:215]
    v_mfma_f32_16x16x32_bf16 v[232:235], v[128:131], v[100:103], v[232:235]
    buffer_load_dwordx4 v14, s[92:95], s33 offen offset:2048 lds
    v_mfma_f32_16x16x32_bf16 v[252:255], v[132:135], v[100:103], v[252:255]
    buffer_load_dwordx4 v15, s[92:95], s33 offen offset:3072 lds
    s_waitcnt vmcnt(9)
    s_waitcnt lgkmcnt(0)
    v_mfma_f32_16x16x32_bf16 v[176:179], v[104:107], v[64:67], v[176:179]
    ds_read_b128 v[84:87], v29 offset:0
    v_mfma_f32_16x16x32_bf16 v[196:199], v[108:111], v[64:67], v[196:199]
    ds_read_b128 v[88:91], v29 offset:32768
    ds_read_b128 v[92:95], v11 offset:0
    v_mfma_f32_16x16x32_bf16 v[216:219], v[112:115], v[64:67], v[216:219]
    ds_read_b128 v[96:99], v11 offset:32768
    v_mfma_f32_16x16x32_bf16 v[236:239], v[116:119], v[64:67], v[236:239]
    ds_read_b128 v[100:103], v25 offset:0
    ds_read_b64_tr_b16 v[120:121], v160 offset:12288
    v_mfma_f32_16x16x32_bf16 v[180:183], v[104:107], v[68:71], v[180:183]
    ds_read_b64_tr_b16 v[122:123], v160 offset:12800
    v_mfma_f32_16x16x32_bf16 v[200:203], v[108:111], v[68:71], v[200:203]
    ds_read_b64_tr_b16 v[124:125], v161 offset:12288
    ds_read_b64_tr_b16 v[126:127], v161 offset:12800
    v_mfma_f32_16x16x32_bf16 v[220:223], v[112:115], v[68:71], v[220:223]
    ds_read_b64_tr_b16 v[128:129], v162 offset:12288
    v_mfma_f32_16x16x32_bf16 v[240:243], v[116:119], v[68:71], v[240:243]
    ds_read_b64_tr_b16 v[130:131], v162 offset:12800
    ds_read_b64_tr_b16 v[132:133], v163 offset:12288
    v_mfma_f32_16x16x32_bf16 v[184:187], v[104:107], v[72:75], v[184:187]
    ds_read_b64_tr_b16 v[134:135], v163 offset:12800
    v_mfma_f32_16x16x32_bf16 v[204:207], v[108:111], v[72:75], v[204:207]
    s_add_u32 m0, s68, 20480
    s_xor_b32 s33, s66, 5
    s_lshl_b32 s33, s33, 18
    buffer_load_dwordx4 v12, s[92:95], s33 offen offset:0 lds
    v_mfma_f32_16x16x32_bf16 v[224:227], v[112:115], v[72:75], v[224:227]
    v_mfma_f32_16x16x32_bf16 v[244:247], v[116:119], v[72:75], v[244:247]
    buffer_load_dwordx4 v13, s[92:95], s33 offen offset:1024 lds
    v_mfma_f32_16x16x32_bf16 v[188:191], v[104:107], v[76:79], v[188:191]
    buffer_load_dwordx4 v14, s[92:95], s33 offen offset:2048 lds
    v_mfma_f32_16x16x32_bf16 v[208:211], v[108:111], v[76:79], v[208:211]
    buffer_load_dwordx4 v15, s[92:95], s33 offen offset:3072 lds
    v_mfma_f32_16x16x32_bf16 v[228:231], v[112:115], v[76:79], v[228:231]
    v_mfma_f32_16x16x32_bf16 v[248:251], v[116:119], v[76:79], v[248:251]
    s_add_u32 m0, s68, 24576
    s_xor_b32 s33, s66, 6
    s_lshl_b32 s33, s33, 18
    buffer_load_dwordx4 v12, s[92:95], s33 offen offset:0 lds
    v_mfma_f32_16x16x32_bf16 v[192:195], v[104:107], v[80:83], v[192:195]
    buffer_load_dwordx4 v13, s[92:95], s33 offen offset:1024 lds
    v_mfma_f32_16x16x32_bf16 v[212:215], v[108:111], v[80:83], v[212:215]
    buffer_load_dwordx4 v14, s[92:95], s33 offen offset:2048 lds
    v_mfma_f32_16x16x32_bf16 v[232:235], v[112:115], v[80:83], v[232:235]
    v_mfma_f32_16x16x32_bf16 v[252:255], v[116:119], v[80:83], v[252:255]
    buffer_load_dwordx4 v15, s[92:95], s33 offen offset:3072 lds
    s_waitcnt vmcnt(8)
    s_waitcnt lgkmcnt(0)
    s_barrier
    v_mfma_f32_16x16x32_bf16 v[176:179], v[120:123], v[84:87], v[176:179]
    ds_read_b128 v[64:67], v26 offset:4096
    ds_read_b128 v[68:71], v26 offset:36864
    v_mfma_f32_16x16x32_bf16 v[196:199], v[124:127], v[84:87], v[196:199]
    ds_read_b128 v[72:75], v8 offset:4096
    v_mfma_f32_16x16x32_bf16 v[216:219], v[128:131], v[84:87], v[216:219]
    ds_read_b128 v[76:79], v8 offset:36864
    ds_read_b128 v[80:83], v22 offset:4096
    v_mfma_f32_16x16x32_bf16 v[236:239], v[132:135], v[84:87], v[236:239]
    ds_read_b64_tr_b16 v[104:105], v160 offset:0
    v_mfma_f32_16x16x32_bf16 v[180:183], v[120:123], v[88:91], v[180:183]
    ds_read_b64_tr_b16 v[106:107], v160 offset:512
    ds_read_b64_tr_b16 v[108:109], v161 offset:0
    v_mfma_f32_16x16x32_bf16 v[200:203], v[124:127], v[88:91], v[200:203]
    ds_read_b64_tr_b16 v[110:111], v161 offset:512
    v_mfma_f32_16x16x32_bf16 v[220:223], v[128:131], v[88:91], v[220:223]
    ds_read_b64_tr_b16 v[112:113], v162 offset:0
    ds_read_b64_tr_b16 v[114:115], v162 offset:512
    v_mfma_f32_16x16x32_bf16 v[240:243], v[132:135], v[88:91], v[240:243]
    ds_read_b64_tr_b16 v[116:117], v163 offset:0
    v_mfma_f32_16x16x32_bf16 v[184:187], v[120:123], v[92:95], v[184:187]
    ds_read_b64_tr_b16 v[118:119], v163 offset:512
    v_mfma_f32_16x16x32_bf16 v[204:207], v[124:127], v[92:95], v[204:207]
    s_add_u32 m0, s69, 8192
    s_lshr_b32 s67, s66, 2
    s_xor_b32 s67, s67, 2
    s_lshl_b32 s67, s67, 8
    buffer_load_dwordx4 v58, s[88:91], s67 offen lds
    v_mfma_f32_16x16x32_bf16 v[224:227], v[128:131], v[92:95], v[224:227]
    s_add_u32 m0, s69, 40960
    s_add_u32 s67, s67, 16384
    buffer_load_dwordx4 v58, s[88:91], s67 offen lds
    v_mfma_f32_16x16x32_bf16 v[244:247], v[132:135], v[92:95], v[244:247]
    s_add_u32 m0, s69, 73728
    s_add_u32 s67, s67, 16384
    buffer_load_dwordx4 v58, s[88:91], s67 offen lds
    v_mfma_f32_16x16x32_bf16 v[188:191], v[120:123], v[96:99], v[188:191]
    s_add_u32 m0, s69, 106496
    s_add_u32 s67, s67, 16384
    buffer_load_dwordx4 v58, s[88:91], s67 offen lds
    v_mfma_f32_16x16x32_bf16 v[208:211], v[124:127], v[96:99], v[208:211]
    v_mfma_f32_16x16x32_bf16 v[228:231], v[128:131], v[96:99], v[228:231]
    s_add_u32 m0, s69, 139264
    s_add_u32 s67, s67, 16384
    buffer_load_dwordx4 v58, s[88:91], s67 offen lds
    v_mfma_f32_16x16x32_bf16 v[248:251], v[132:135], v[96:99], v[248:251]
    s_add_u32 m0, s68, 28672
    s_xor_b32 s33, s66, 7
    s_lshl_b32 s33, s33, 18
    buffer_load_dwordx4 v12, s[92:95], s33 offen offset:0 lds
    v_mfma_f32_16x16x32_bf16 v[192:195], v[120:123], v[100:103], v[192:195]
    buffer_load_dwordx4 v13, s[92:95], s33 offen offset:1024 lds
    v_mfma_f32_16x16x32_bf16 v[212:215], v[124:127], v[100:103], v[212:215]
    v_mfma_f32_16x16x32_bf16 v[232:235], v[128:131], v[100:103], v[232:235]
    buffer_load_dwordx4 v14, s[92:95], s33 offen offset:2048 lds
    v_mfma_f32_16x16x32_bf16 v[252:255], v[132:135], v[100:103], v[252:255]
    buffer_load_dwordx4 v15, s[92:95], s33 offen offset:3072 lds
    s_waitcnt vmcnt(13)
    s_waitcnt lgkmcnt(0)
    s_lshl_b32 s30, s65, 7
    s_lshl_b32 s31, s65, 11
    v_xor_b32 v40, s30, v40
    v_add_u32 v40, s31, v40
    v_add_u32 v44, s31, v44
    v_xor_b32 v41, s30, v41
    v_add_u32 v41, s31, v41
    v_add_u32 v45, s31, v45
    s_add_u32 s72, s25, s31
    v_mfma_f32_16x16x32_bf16 v[176:179], v[104:107], v[64:67], v[176:179]
    ds_read_b128 v[84:87], v27 offset:4096
    v_mfma_f32_16x16x32_bf16 v[196:199], v[108:111], v[64:67], v[196:199]
    ds_read_b128 v[88:91], v27 offset:36864
    ds_read_b128 v[92:95], v9 offset:4096
    v_mfma_f32_16x16x32_bf16 v[216:219], v[112:115], v[64:67], v[216:219]
    ds_read_b128 v[96:99], v9 offset:36864
    v_mfma_f32_16x16x32_bf16 v[236:239], v[116:119], v[64:67], v[236:239]
    ds_read_b128 v[100:103], v23 offset:4096
    v_mfma_f32_16x16x32_bf16 v[180:183], v[104:107], v[68:71], v[180:183]
    ds_read_b64_tr_b16 v[120:121], v160 offset:4096
    v_mfma_f32_16x16x32_bf16 v[200:203], v[108:111], v[68:71], v[200:203]
    ds_read_b64_tr_b16 v[122:123], v160 offset:4608
    ds_read_b64_tr_b16 v[124:125], v161 offset:4096
    v_mfma_f32_16x16x32_bf16 v[220:223], v[112:115], v[68:71], v[220:223]
    ds_read_b64_tr_b16 v[126:127], v161 offset:4608
    v_mfma_f32_16x16x32_bf16 v[240:243], v[116:119], v[68:71], v[240:243]
    ds_read_b64_tr_b16 v[128:129], v162 offset:4096
    v_mfma_f32_16x16x32_bf16 v[184:187], v[104:107], v[72:75], v[184:187]
    ds_read_b64_tr_b16 v[130:131], v162 offset:4608
    v_mfma_f32_16x16x32_bf16 v[204:207], v[108:111], v[72:75], v[204:207]
    ds_read_b64_tr_b16 v[132:133], v163 offset:4096
    ds_read_b64_tr_b16 v[134:135], v163 offset:4608
    v_mfma_f32_16x16x32_bf16 v[224:227], v[112:115], v[72:75], v[224:227]
    v_mfma_f32_16x16x32_bf16 v[244:247], v[116:119], v[72:75], v[244:247]
    s_add_u32 m0, s68, 16384
    s_xor_b32 s33, s66, 8
    s_lshl_b32 s33, s33, 18
    buffer_load_dwordx4 v12, s[92:95], s33 offen offset:0 lds
    v_mfma_f32_16x16x32_bf16 v[188:191], v[104:107], v[76:79], v[188:191]
    buffer_load_dwordx4 v13, s[92:95], s33 offen offset:1024 lds
    v_mfma_f32_16x16x32_bf16 v[208:211], v[108:111], v[76:79], v[208:211]
    v_mfma_f32_16x16x32_bf16 v[228:231], v[112:115], v[76:79], v[228:231]
    buffer_load_dwordx4 v14, s[92:95], s33 offen offset:2048 lds
    v_mfma_f32_16x16x32_bf16 v[248:251], v[116:119], v[76:79], v[248:251]
    buffer_load_dwordx4 v15, s[92:95], s33 offen offset:3072 lds
    v_mfma_f32_16x16x32_bf16 v[192:195], v[104:107], v[80:83], v[192:195]
    v_mfma_f32_16x16x32_bf16 v[212:215], v[108:111], v[80:83], v[212:215]
    s_add_u32 m0, s72, 12288
    s_xor_b32 s30, s3, 4096
    buffer_load_dwordx4 v44, s[8:11], s30 offen offset:0 nt lds
    v_mfma_f32_16x16x32_bf16 v[232:235], v[112:115], v[80:83], v[232:235]
    v_mfma_f32_16x16x32_bf16 v[252:255], v[116:119], v[80:83], v[252:255]
    buffer_load_dwordx4 v45, s[8:11], s30 offen offset:1024 nt lds
    s_waitcnt vmcnt(15)
    s_waitcnt lgkmcnt(0)
    v_mfma_f32_16x16x32_bf16 v[176:179], v[120:123], v[84:87], v[176:179]
    ds_read_b128 v[64:67], v28 offset:4096
    ds_read_b128 v[68:71], v28 offset:36864
    v_mfma_f32_16x16x32_bf16 v[196:199], v[124:127], v[84:87], v[196:199]
    ds_read_b128 v[72:75], v10 offset:4096
    ds_read_b128 v[76:79], v10 offset:36864
    v_mfma_f32_16x16x32_bf16 v[216:219], v[128:131], v[84:87], v[216:219]
    ds_read_b128 v[80:83], v24 offset:4096
    v_mfma_f32_16x16x32_bf16 v[236:239], v[132:135], v[84:87], v[236:239]
    ds_read_b64_tr_b16 v[104:105], v160 offset:8192
    ds_read_b64_tr_b16 v[106:107], v160 offset:8704
    v_mfma_f32_16x16x32_bf16 v[180:183], v[120:123], v[88:91], v[180:183]
    ds_read_b64_tr_b16 v[108:109], v161 offset:8192
    ds_read_b64_tr_b16 v[110:111], v161 offset:8704
    v_mfma_f32_16x16x32_bf16 v[200:203], v[124:127], v[88:91], v[200:203]
    ds_read_b64_tr_b16 v[112:113], v162 offset:8192
    ds_read_b64_tr_b16 v[114:115], v162 offset:8704
    v_mfma_f32_16x16x32_bf16 v[220:223], v[128:131], v[88:91], v[220:223]
    ds_read_b64_tr_b16 v[116:117], v163 offset:8192
    v_mfma_f32_16x16x32_bf16 v[240:243], v[132:135], v[88:91], v[240:243]
    ds_read_b64_tr_b16 v[118:119], v163 offset:8704
    s_add_u32 m0, s69, 143360
    s_lshr_b32 s67, s66, 2
    s_xor_b32 s67, s67, 3
    s_lshl_b32 s67, s67, 8
    buffer_load_dwordx4 v58, s[88:91], s67 offen lds
    v_mfma_f32_16x16x32_bf16 v[184:187], v[120:123], v[92:95], v[184:187]
    v_mfma_f32_16x16x32_bf16 v[204:207], v[124:127], v[92:95], v[204:207]
    s_add_u32 m0, s69, 147456
    s_add_u32 s67, s67, 16384
    buffer_load_dwordx4 v58, s[88:91], s67 offen lds
    v_mfma_f32_16x16x32_bf16 v[224:227], v[128:131], v[92:95], v[224:227]
    s_add_u32 m0, s69, 151552
    s_add_u32 s67, s67, 16384
    buffer_load_dwordx4 v58, s[88:91], s67 offen lds
    v_mfma_f32_16x16x32_bf16 v[244:247], v[132:135], v[92:95], v[244:247]
    s_add_u32 m0, s69, 155648
    s_add_u32 s67, s67, 16384
    buffer_load_dwordx4 v58, s[88:91], s67 offen lds
    v_mfma_f32_16x16x32_bf16 v[188:191], v[120:123], v[96:99], v[188:191]
    s_add_u32 m0, s69, 159744
    s_add_u32 s67, s67, 16384
    buffer_load_dwordx4 v58, s[88:91], s67 offen lds
    v_mfma_f32_16x16x32_bf16 v[208:211], v[124:127], v[96:99], v[208:211]
    s_add_u32 m0, s68, 20480
    s_xor_b32 s33, s66, 9
    s_lshl_b32 s33, s33, 18
    buffer_load_dwordx4 v12, s[92:95], s33 offen offset:0 lds
    v_mfma_f32_16x16x32_bf16 v[228:231], v[128:131], v[96:99], v[228:231]
    buffer_load_dwordx4 v13, s[92:95], s33 offen offset:1024 lds
    v_mfma_f32_16x16x32_bf16 v[248:251], v[132:135], v[96:99], v[248:251]
    buffer_load_dwordx4 v14, s[92:95], s33 offen offset:2048 lds
    v_mfma_f32_16x16x32_bf16 v[192:195], v[120:123], v[100:103], v[192:195]
    v_mfma_f32_16x16x32_bf16 v[212:215], v[124:127], v[100:103], v[212:215]
    buffer_load_dwordx4 v15, s[92:95], s33 offen offset:3072 lds
    v_mfma_f32_16x16x32_bf16 v[232:235], v[128:131], v[100:103], v[232:235]
    s_add_u32 m0, s72, 45056
    s_xor_b32 s30, s3, 12288
    buffer_load_dwordx4 v44, s[8:11], s30 offen offset:0 nt lds
    v_mfma_f32_16x16x32_bf16 v[252:255], v[132:135], v[100:103], v[252:255]
    buffer_load_dwordx4 v45, s[8:11], s30 offen offset:1024 nt lds
    s_waitcnt vmcnt(17)
    s_waitcnt lgkmcnt(0)
    v_mfma_f32_16x16x32_bf16 v[176:179], v[104:107], v[64:67], v[176:179]
    ds_read_b128 v[84:87], v29 offset:4096
    v_mfma_f32_16x16x32_bf16 v[196:199], v[108:111], v[64:67], v[196:199]
    ds_read_b128 v[88:91], v29 offset:36864
    ds_read_b128 v[92:95], v11 offset:4096
    v_mfma_f32_16x16x32_bf16 v[216:219], v[112:115], v[64:67], v[216:219]
    ds_read_b128 v[96:99], v11 offset:36864
    v_mfma_f32_16x16x32_bf16 v[236:239], v[116:119], v[64:67], v[236:239]
    ds_read_b128 v[100:103], v25 offset:4096
    v_mfma_f32_16x16x32_bf16 v[180:183], v[104:107], v[68:71], v[180:183]
    ds_read_b64_tr_b16 v[120:121], v160 offset:12288
    v_mfma_f32_16x16x32_bf16 v[200:203], v[108:111], v[68:71], v[200:203]
    ds_read_b64_tr_b16 v[122:123], v160 offset:12800
    ds_read_b64_tr_b16 v[124:125], v161 offset:12288
    v_mfma_f32_16x16x32_bf16 v[220:223], v[112:115], v[68:71], v[220:223]
    ds_read_b64_tr_b16 v[126:127], v161 offset:12800
    v_mfma_f32_16x16x32_bf16 v[240:243], v[116:119], v[68:71], v[240:243]
    ds_read_b64_tr_b16 v[128:129], v162 offset:12288
    v_mfma_f32_16x16x32_bf16 v[184:187], v[104:107], v[72:75], v[184:187]
    ds_read_b64_tr_b16 v[130:131], v162 offset:12800
    v_mfma_f32_16x16x32_bf16 v[204:207], v[108:111], v[72:75], v[204:207]
    ds_read_b64_tr_b16 v[132:133], v163 offset:12288
    ds_read_b64_tr_b16 v[134:135], v163 offset:12800
    v_mfma_f32_16x16x32_bf16 v[224:227], v[112:115], v[72:75], v[224:227]
    v_mfma_f32_16x16x32_bf16 v[244:247], v[116:119], v[72:75], v[244:247]
    s_add_u32 m0, s68, 24576
    s_xor_b32 s33, s66, 10
    s_lshl_b32 s33, s33, 18
    buffer_load_dwordx4 v12, s[92:95], s33 offen offset:0 lds
    v_mfma_f32_16x16x32_bf16 v[188:191], v[104:107], v[76:79], v[188:191]
    buffer_load_dwordx4 v13, s[92:95], s33 offen offset:1024 lds
    v_mfma_f32_16x16x32_bf16 v[208:211], v[108:111], v[76:79], v[208:211]
    v_mfma_f32_16x16x32_bf16 v[228:231], v[112:115], v[76:79], v[228:231]
    buffer_load_dwordx4 v14, s[92:95], s33 offen offset:2048 lds
    v_mfma_f32_16x16x32_bf16 v[248:251], v[116:119], v[76:79], v[248:251]
    buffer_load_dwordx4 v15, s[92:95], s33 offen offset:3072 lds
    v_mfma_f32_16x16x32_bf16 v[192:195], v[104:107], v[80:83], v[192:195]
    v_mfma_f32_16x16x32_bf16 v[212:215], v[108:111], v[80:83], v[212:215]
    s_add_u32 m0, s72, 0
    s_xor_b32 s30, s3, 0
    buffer_load_dwordx4 v40, s[4:7], s30 offen offset:0 nt lds
    v_mfma_f32_16x16x32_bf16 v[232:235], v[112:115], v[80:83], v[232:235]
    v_mfma_f32_16x16x32_bf16 v[252:255], v[116:119], v[80:83], v[252:255]
    buffer_load_dwordx4 v41, s[4:7], s30 offen offset:1024 nt lds
    s_waitcnt vmcnt(19)
    s_waitcnt lgkmcnt(0)
    s_barrier
    v_mfma_f32_16x16x32_bf16 v[176:179], v[120:123], v[84:87], v[176:179]
    ds_read_b128 v[64:67], v26 offset:8192
    v_mfma_f32_16x16x32_bf16 v[196:199], v[124:127], v[84:87], v[196:199]
    ds_read_b128 v[68:71], v26 offset:40960
    ds_read_b128 v[72:75], v8 offset:8192
    v_mfma_f32_16x16x32_bf16 v[216:219], v[128:131], v[84:87], v[216:219]
    ds_read_b128 v[76:79], v8 offset:40960
    v_mfma_f32_16x16x32_bf16 v[236:239], v[132:135], v[84:87], v[236:239]
    ds_read_b128 v[80:83], v22 offset:8192
    v_mfma_f32_16x16x32_bf16 v[180:183], v[120:123], v[88:91], v[180:183]
    ds_read_b64_tr_b16 v[104:105], v160 offset:0
    v_mfma_f32_16x16x32_bf16 v[200:203], v[124:127], v[88:91], v[200:203]
    ds_read_b64_tr_b16 v[106:107], v160 offset:512
    ds_read_b64_tr_b16 v[108:109], v161 offset:0
    v_mfma_f32_16x16x32_bf16 v[220:223], v[128:131], v[88:91], v[220:223]
    ds_read_b64_tr_b16 v[110:111], v161 offset:512
    v_mfma_f32_16x16x32_bf16 v[240:243], v[132:135], v[88:91], v[240:243]
    ds_read_b64_tr_b16 v[112:113], v162 offset:0
    v_mfma_f32_16x16x32_bf16 v[184:187], v[120:123], v[92:95], v[184:187]
    ds_read_b64_tr_b16 v[114:115], v162 offset:512
    v_mfma_f32_16x16x32_bf16 v[204:207], v[124:127], v[92:95], v[204:207]
    ds_read_b64_tr_b16 v[116:117], v163 offset:0
    ds_read_b64_tr_b16 v[118:119], v163 offset:512
    v_mfma_f32_16x16x32_bf16 v[224:227], v[128:131], v[92:95], v[224:227]
    v_mfma_f32_16x16x32_bf16 v[244:247], v[132:135], v[92:95], v[244:247]
    s_add_u32 m0, s68, 28672
    s_xor_b32 s33, s66, 11
    s_lshl_b32 s33, s33, 18
    buffer_load_dwordx4 v12, s[92:95], s33 offen offset:0 lds
    v_mfma_f32_16x16x32_bf16 v[188:191], v[120:123], v[96:99], v[188:191]
    buffer_load_dwordx4 v13, s[92:95], s33 offen offset:1024 lds
    v_mfma_f32_16x16x32_bf16 v[208:211], v[124:127], v[96:99], v[208:211]
    v_mfma_f32_16x16x32_bf16 v[228:231], v[128:131], v[96:99], v[228:231]
    buffer_load_dwordx4 v14, s[92:95], s33 offen offset:2048 lds
    v_mfma_f32_16x16x32_bf16 v[248:251], v[132:135], v[96:99], v[248:251]
    buffer_load_dwordx4 v15, s[92:95], s33 offen offset:3072 lds
    v_mfma_f32_16x16x32_bf16 v[192:195], v[120:123], v[100:103], v[192:195]
    v_mfma_f32_16x16x32_bf16 v[212:215], v[124:127], v[100:103], v[212:215]
    s_add_u32 m0, s72, 32768
    s_xor_b32 s30, s3, 8192
    buffer_load_dwordx4 v40, s[4:7], s30 offen offset:0 nt lds
    v_mfma_f32_16x16x32_bf16 v[232:235], v[128:131], v[100:103], v[232:235]
    v_mfma_f32_16x16x32_bf16 v[252:255], v[132:135], v[100:103], v[252:255]
    buffer_load_dwordx4 v41, s[4:7], s30 offen offset:1024 nt lds
    s_waitcnt vmcnt(14)
    s_waitcnt lgkmcnt(0)
    v_mfma_f32_16x16x32_bf16 v[176:179], v[104:107], v[64:67], v[176:179]
    ds_read_b128 v[84:87], v27 offset:8192
    v_mfma_f32_16x16x32_bf16 v[196:199], v[108:111], v[64:67], v[196:199]
    ds_read_b128 v[88:91], v27 offset:40960
    ds_read_b128 v[92:95], v9 offset:8192
    v_mfma_f32_16x16x32_bf16 v[216:219], v[112:115], v[64:67], v[216:219]
    ds_read_b128 v[96:99], v9 offset:40960
    v_mfma_f32_16x16x32_bf16 v[236:239], v[116:119], v[64:67], v[236:239]
    ds_read_b128 v[100:103], v23 offset:8192
    v_mfma_f32_16x16x32_bf16 v[180:183], v[104:107], v[68:71], v[180:183]
    ds_read_b64_tr_b16 v[120:121], v160 offset:4096
    v_mfma_f32_16x16x32_bf16 v[200:203], v[108:111], v[68:71], v[200:203]
    ds_read_b64_tr_b16 v[122:123], v160 offset:4608
    ds_read_b64_tr_b16 v[124:125], v161 offset:4096
    v_mfma_f32_16x16x32_bf16 v[220:223], v[112:115], v[68:71], v[220:223]
    ds_read_b64_tr_b16 v[126:127], v161 offset:4608
    v_mfma_f32_16x16x32_bf16 v[240:243], v[116:119], v[68:71], v[240:243]
    ds_read_b64_tr_b16 v[128:129], v162 offset:4096
    v_mfma_f32_16x16x32_bf16 v[184:187], v[104:107], v[72:75], v[184:187]
    ds_read_b64_tr_b16 v[130:131], v162 offset:4608
    v_mfma_f32_16x16x32_bf16 v[204:207], v[108:111], v[72:75], v[204:207]
    ds_read_b64_tr_b16 v[132:133], v163 offset:4096
    ds_read_b64_tr_b16 v[134:135], v163 offset:4608
    v_mfma_f32_16x16x32_bf16 v[224:227], v[112:115], v[72:75], v[224:227]
    v_mfma_f32_16x16x32_bf16 v[244:247], v[116:119], v[72:75], v[244:247]
    s_add_u32 m0, s68, 16384
    s_xor_b32 s33, s66, 12
    s_lshl_b32 s33, s33, 18
    buffer_load_dwordx4 v12, s[92:95], s33 offen offset:0 lds
    v_mfma_f32_16x16x32_bf16 v[188:191], v[104:107], v[76:79], v[188:191]
    buffer_load_dwordx4 v13, s[92:95], s33 offen offset:1024 lds
    v_mfma_f32_16x16x32_bf16 v[208:211], v[108:111], v[76:79], v[208:211]
    v_mfma_f32_16x16x32_bf16 v[228:231], v[112:115], v[76:79], v[228:231]
    buffer_load_dwordx4 v14, s[92:95], s33 offen offset:2048 lds
    v_mfma_f32_16x16x32_bf16 v[248:251], v[116:119], v[76:79], v[248:251]
    buffer_load_dwordx4 v15, s[92:95], s33 offen offset:3072 lds
    v_mfma_f32_16x16x32_bf16 v[192:195], v[104:107], v[80:83], v[192:195]
    v_mfma_f32_16x16x32_bf16 v[212:215], v[108:111], v[80:83], v[212:215]
    s_add_u32 m0, s72, 4096
    s_xor_b32 s30, s3, 4096
    buffer_load_dwordx4 v40, s[4:7], s30 offen offset:0 nt lds
    v_mfma_f32_16x16x32_bf16 v[232:235], v[112:115], v[80:83], v[232:235]
    v_mfma_f32_16x16x32_bf16 v[252:255], v[116:119], v[80:83], v[252:255]
    buffer_load_dwordx4 v41, s[4:7], s30 offen offset:1024 nt lds
    s_waitcnt vmcnt(14)
    s_waitcnt lgkmcnt(0)
    v_mfma_f32_16x16x32_bf16 v[176:179], v[120:123], v[84:87], v[176:179]
    ds_read_b128 v[64:67], v28 offset:8192
    v_mfma_f32_16x16x32_bf16 v[196:199], v[124:127], v[84:87], v[196:199]
    ds_read_b128 v[68:71], v28 offset:40960
    ds_read_b128 v[72:75], v10 offset:8192
    v_mfma_f32_16x16x32_bf16 v[216:219], v[128:131], v[84:87], v[216:219]
    ds_read_b128 v[76:79], v10 offset:40960
    v_mfma_f32_16x16x32_bf16 v[236:239], v[132:135], v[84:87], v[236:239]
    ds_read_b128 v[80:83], v24 offset:8192
    v_mfma_f32_16x16x32_bf16 v[180:183], v[120:123], v[88:91], v[180:183]
    ds_read_b64_tr_b16 v[104:105], v160 offset:8192
    v_mfma_f32_16x16x32_bf16 v[200:203], v[124:127], v[88:91], v[200:203]
    ds_read_b64_tr_b16 v[106:107], v160 offset:8704
    ds_read_b64_tr_b16 v[108:109], v161 offset:8192
    v_mfma_f32_16x16x32_bf16 v[220:223], v[128:131], v[88:91], v[220:223]
    ds_read_b64_tr_b16 v[110:111], v161 offset:8704
    v_mfma_f32_16x16x32_bf16 v[240:243], v[132:135], v[88:91], v[240:243]
    ds_read_b64_tr_b16 v[112:113], v162 offset:8192
    v_mfma_f32_16x16x32_bf16 v[184:187], v[120:123], v[92:95], v[184:187]
    ds_read_b64_tr_b16 v[114:115], v162 offset:8704
    v_mfma_f32_16x16x32_bf16 v[204:207], v[124:127], v[92:95], v[204:207]
    ds_read_b64_tr_b16 v[116:117], v163 offset:8192
    ds_read_b64_tr_b16 v[118:119], v163 offset:8704
    v_mfma_f32_16x16x32_bf16 v[224:227], v[128:131], v[92:95], v[224:227]
    v_mfma_f32_16x16x32_bf16 v[244:247], v[132:135], v[92:95], v[244:247]
    s_add_u32 m0, s68, 20480
    s_xor_b32 s33, s66, 13
    s_lshl_b32 s33, s33, 18
    buffer_load_dwordx4 v12, s[92:95], s33 offen offset:0 lds
    v_mfma_f32_16x16x32_bf16 v[188:191], v[120:123], v[96:99], v[188:191]
    buffer_load_dwordx4 v13, s[92:95], s33 offen offset:1024 lds
    v_mfma_f32_16x16x32_bf16 v[208:211], v[124:127], v[96:99], v[208:211]
    v_mfma_f32_16x16x32_bf16 v[228:231], v[128:131], v[96:99], v[228:231]
    buffer_load_dwordx4 v14, s[92:95], s33 offen offset:2048 lds
    v_mfma_f32_16x16x32_bf16 v[248:251], v[132:135], v[96:99], v[248:251]
    buffer_load_dwordx4 v15, s[92:95], s33 offen offset:3072 lds
    v_mfma_f32_16x16x32_bf16 v[192:195], v[120:123], v[100:103], v[192:195]
    v_mfma_f32_16x16x32_bf16 v[212:215], v[124:127], v[100:103], v[212:215]
    s_add_u32 m0, s72, 36864
    s_xor_b32 s30, s3, 12288
    buffer_load_dwordx4 v40, s[4:7], s30 offen offset:0 nt lds
    v_mfma_f32_16x16x32_bf16 v[232:235], v[128:131], v[100:103], v[232:235]
    v_mfma_f32_16x16x32_bf16 v[252:255], v[132:135], v[100:103], v[252:255]
    buffer_load_dwordx4 v41, s[4:7], s30 offen offset:1024 nt lds
    s_waitcnt vmcnt(14)
    s_waitcnt lgkmcnt(0)
    v_mfma_f32_16x16x32_bf16 v[176:179], v[104:107], v[64:67], v[176:179]
    ds_read_b128 v[84:87], v29 offset:8192
    v_mfma_f32_16x16x32_bf16 v[196:199], v[108:111], v[64:67], v[196:199]
    ds_read_b128 v[88:91], v29 offset:40960
    v_mfma_f32_16x16x32_bf16 v[216:219], v[112:115], v[64:67], v[216:219]
    ds_read_b128 v[92:95], v11 offset:8192
    v_mfma_f32_16x16x32_bf16 v[236:239], v[116:119], v[64:67], v[236:239]
    ds_read_b128 v[96:99], v11 offset:40960
    v_mfma_f32_16x16x32_bf16 v[180:183], v[104:107], v[68:71], v[180:183]
    ds_read_b128 v[100:103], v25 offset:8192
    v_mfma_f32_16x16x32_bf16 v[200:203], v[108:111], v[68:71], v[200:203]
    ds_read_b64_tr_b16 v[120:121], v160 offset:12288
    v_mfma_f32_16x16x32_bf16 v[220:223], v[112:115], v[68:71], v[220:223]
    ds_read_b64_tr_b16 v[122:123], v160 offset:12800
    v_mfma_f32_16x16x32_bf16 v[240:243], v[116:119], v[68:71], v[240:243]
    ds_read_b64_tr_b16 v[124:125], v161 offset:12288
    v_mfma_f32_16x16x32_bf16 v[184:187], v[104:107], v[72:75], v[184:187]
    ds_read_b64_tr_b16 v[126:127], v161 offset:12800
    v_mfma_f32_16x16x32_bf16 v[204:207], v[108:111], v[72:75], v[204:207]
    ds_read_b64_tr_b16 v[128:129], v162 offset:12288
    ds_read_b64_tr_b16 v[130:131], v162 offset:12800
    v_mfma_f32_16x16x32_bf16 v[224:227], v[112:115], v[72:75], v[224:227]
    ds_read_b64_tr_b16 v[132:133], v163 offset:12288
    v_mfma_f32_16x16x32_bf16 v[244:247], v[116:119], v[72:75], v[244:247]
    ds_read_b64_tr_b16 v[134:135], v163 offset:12800
    v_mfma_f32_16x16x32_bf16 v[188:191], v[104:107], v[76:79], v[188:191]
    v_mfma_f32_16x16x32_bf16 v[208:211], v[108:111], v[76:79], v[208:211]
    s_add_u32 m0, s68, 24576
    s_xor_b32 s33, s66, 14
    s_lshl_b32 s33, s33, 18
    buffer_load_dwordx4 v12, s[92:95], s33 offen offset:0 lds
    v_mfma_f32_16x16x32_bf16 v[228:231], v[112:115], v[76:79], v[228:231]
    v_mfma_f32_16x16x32_bf16 v[248:251], v[116:119], v[76:79], v[248:251]
    buffer_load_dwordx4 v13, s[92:95], s33 offen offset:1024 lds
    v_mfma_f32_16x16x32_bf16 v[192:195], v[104:107], v[80:83], v[192:195]
    v_mfma_f32_16x16x32_bf16 v[212:215], v[108:111], v[80:83], v[212:215]
    buffer_load_dwordx4 v14, s[92:95], s33 offen offset:2048 lds
    v_mfma_f32_16x16x32_bf16 v[232:235], v[112:115], v[80:83], v[232:235]
    v_mfma_f32_16x16x32_bf16 v[252:255], v[116:119], v[80:83], v[252:255]
    buffer_load_dwordx4 v15, s[92:95], s33 offen offset:3072 lds
    s_waitcnt vmcnt(12)
    s_waitcnt lgkmcnt(0)
    s_barrier
    v_mfma_f32_16x16x32_bf16 v[176:179], v[120:123], v[84:87], v[176:179]
    ds_read_b128 v[64:67], v22 offset:12288
    v_mfma_f32_16x16x32_bf16 v[196:199], v[124:127], v[84:87], v[196:199]
    ds_read_b128 v[68:71], v22 offset:16384
    v_mfma_f32_16x16x32_bf16 v[216:219], v[128:131], v[84:87], v[216:219]
    ds_read_b128 v[72:75], v22 offset:20480
    v_mfma_f32_16x16x32_bf16 v[236:239], v[132:135], v[84:87], v[236:239]
    ds_read_b128 v[76:79], v22 offset:24576
    v_mfma_f32_16x16x32_bf16 v[180:183], v[120:123], v[88:91], v[180:183]
    ds_read_b128 v[80:83], v22 offset:28672
    v_mfma_f32_16x16x32_bf16 v[200:203], v[124:127], v[88:91], v[200:203]
    ds_read_b64_tr_b16 v[104:105], v160 offset:0
    v_mfma_f32_16x16x32_bf16 v[220:223], v[128:131], v[88:91], v[220:223]
    ds_read_b64_tr_b16 v[106:107], v160 offset:512
    v_mfma_f32_16x16x32_bf16 v[240:243], v[132:135], v[88:91], v[240:243]
    ds_read_b64_tr_b16 v[108:109], v161 offset:0
    v_mfma_f32_16x16x32_bf16 v[184:187], v[120:123], v[92:95], v[184:187]
    ds_read_b64_tr_b16 v[110:111], v161 offset:512
    v_mfma_f32_16x16x32_bf16 v[204:207], v[124:127], v[92:95], v[204:207]
    ds_read_b64_tr_b16 v[112:113], v162 offset:0
    ds_read_b64_tr_b16 v[114:115], v162 offset:512
    v_mfma_f32_16x16x32_bf16 v[224:227], v[128:131], v[92:95], v[224:227]
    ds_read_b64_tr_b16 v[116:117], v163 offset:0
    v_mfma_f32_16x16x32_bf16 v[244:247], v[132:135], v[92:95], v[244:247]
    ds_read_b64_tr_b16 v[118:119], v163 offset:512
    v_mfma_f32_16x16x32_bf16 v[188:191], v[120:123], v[96:99], v[188:191]
    v_mfma_f32_16x16x32_bf16 v[208:211], v[124:127], v[96:99], v[208:211]
    s_add_u32 m0, s68, 28672
    s_xor_b32 s33, s66, 15
    s_lshl_b32 s33, s33, 18
    buffer_load_dwordx4 v12, s[92:95], s33 offen offset:0 lds
    v_mfma_f32_16x16x32_bf16 v[228:231], v[128:131], v[96:99], v[228:231]
    v_mfma_f32_16x16x32_bf16 v[248:251], v[132:135], v[96:99], v[248:251]
    buffer_load_dwordx4 v13, s[92:95], s33 offen offset:1024 lds
    v_mfma_f32_16x16x32_bf16 v[192:195], v[120:123], v[100:103], v[192:195]
    v_mfma_f32_16x16x32_bf16 v[212:215], v[124:127], v[100:103], v[212:215]
    buffer_load_dwordx4 v14, s[92:95], s33 offen offset:2048 lds
    v_mfma_f32_16x16x32_bf16 v[232:235], v[128:131], v[100:103], v[232:235]
    v_mfma_f32_16x16x32_bf16 v[252:255], v[132:135], v[100:103], v[252:255]
    buffer_load_dwordx4 v15, s[92:95], s33 offen offset:3072 lds
    s_waitcnt vmcnt(10)
    s_waitcnt lgkmcnt(0)
    v_mfma_f32_16x16x32_bf16 v[176:179], v[104:107], v[64:67], v[176:179]
    ds_read_b128 v[84:87], v23 offset:12288
    v_mfma_f32_16x16x32_bf16 v[196:199], v[108:111], v[64:67], v[196:199]
    ds_read_b128 v[88:91], v23 offset:16384
    v_mfma_f32_16x16x32_bf16 v[216:219], v[112:115], v[64:67], v[216:219]
    ds_read_b128 v[92:95], v23 offset:20480
    v_mfma_f32_16x16x32_bf16 v[236:239], v[116:119], v[64:67], v[236:239]
    v_mfma_f32_16x16x32_bf16 v[180:183], v[104:107], v[68:71], v[180:183]
    ds_read_b128 v[96:99], v23 offset:24576
    v_mfma_f32_16x16x32_bf16 v[200:203], v[108:111], v[68:71], v[200:203]
    ds_read_b128 v[100:103], v23 offset:28672
    v_mfma_f32_16x16x32_bf16 v[220:223], v[112:115], v[68:71], v[220:223]
    ds_read_b64_tr_b16 v[120:121], v160 offset:4096
    v_mfma_f32_16x16x32_bf16 v[240:243], v[116:119], v[68:71], v[240:243]
    ds_read_b64_tr_b16 v[122:123], v160 offset:4608
    v_mfma_f32_16x16x32_bf16 v[184:187], v[104:107], v[72:75], v[184:187]
    ds_read_b64_tr_b16 v[124:125], v161 offset:4096
    v_mfma_f32_16x16x32_bf16 v[204:207], v[108:111], v[72:75], v[204:207]
    ds_read_b64_tr_b16 v[126:127], v161 offset:4608
    v_mfma_f32_16x16x32_bf16 v[224:227], v[112:115], v[72:75], v[224:227]
    v_mfma_f32_16x16x32_bf16 v[244:247], v[116:119], v[72:75], v[244:247]
    ds_read_b64_tr_b16 v[128:129], v162 offset:4096
    v_mfma_f32_16x16x32_bf16 v[188:191], v[104:107], v[76:79], v[188:191]
    ds_read_b64_tr_b16 v[130:131], v162 offset:4608
    v_mfma_f32_16x16x32_bf16 v[208:211], v[108:111], v[76:79], v[208:211]
    ds_read_b64_tr_b16 v[132:133], v163 offset:4096
    v_mfma_f32_16x16x32_bf16 v[228:231], v[112:115], v[76:79], v[228:231]
    ds_read_b64_tr_b16 v[134:135], v163 offset:4608
    v_mfma_f32_16x16x32_bf16 v[248:251], v[116:119], v[76:79], v[248:251]
    v_mfma_f32_16x16x32_bf16 v[192:195], v[104:107], v[80:83], v[192:195]
    s_add_u32 m0, s72, 8192
    s_xor_b32 s30, s3, 0
    buffer_load_dwordx4 v44, s[8:11], s30 offen offset:0 nt lds
    v_mfma_f32_16x16x32_bf16 v[212:215], v[108:111], v[80:83], v[212:215]
    v_mfma_f32_16x16x32_bf16 v[232:235], v[112:115], v[80:83], v[232:235]
    buffer_load_dwordx4 v45, s[8:11], s30 offen offset:1024 nt lds
    v_mfma_f32_16x16x32_bf16 v[252:255], v[116:119], v[80:83], v[252:255]
    s_waitcnt vmcnt(6)
    s_waitcnt lgkmcnt(0)
    v_mfma_f32_16x16x32_bf16 v[176:179], v[120:123], v[84:87], v[176:179]
    ds_read_b128 v[64:67], v24 offset:12288
    v_mfma_f32_16x16x32_bf16 v[196:199], v[124:127], v[84:87], v[196:199]
    ds_read_b128 v[68:71], v24 offset:16384
    v_mfma_f32_16x16x32_bf16 v[216:219], v[128:131], v[84:87], v[216:219]
    ds_read_b128 v[72:75], v24 offset:20480
    v_mfma_f32_16x16x32_bf16 v[236:239], v[132:135], v[84:87], v[236:239]
    v_mfma_f32_16x16x32_bf16 v[180:183], v[120:123], v[88:91], v[180:183]
    ds_read_b128 v[76:79], v24 offset:24576
    v_mfma_f32_16x16x32_bf16 v[200:203], v[124:127], v[88:91], v[200:203]
    ds_read_b128 v[80:83], v24 offset:28672
    v_mfma_f32_16x16x32_bf16 v[220:223], v[128:131], v[88:91], v[220:223]
    ds_read_b64_tr_b16 v[104:105], v160 offset:8192
    v_mfma_f32_16x16x32_bf16 v[240:243], v[132:135], v[88:91], v[240:243]
    ds_read_b64_tr_b16 v[106:107], v160 offset:8704
    v_mfma_f32_16x16x32_bf16 v[184:187], v[120:123], v[92:95], v[184:187]
    ds_read_b64_tr_b16 v[108:109], v161 offset:8192
    v_mfma_f32_16x16x32_bf16 v[204:207], v[124:127], v[92:95], v[204:207]
    ds_read_b64_tr_b16 v[110:111], v161 offset:8704
    v_mfma_f32_16x16x32_bf16 v[224:227], v[128:131], v[92:95], v[224:227]
    v_mfma_f32_16x16x32_bf16 v[244:247], v[132:135], v[92:95], v[244:247]
    ds_read_b64_tr_b16 v[112:113], v162 offset:8192
    v_mfma_f32_16x16x32_bf16 v[188:191], v[120:123], v[96:99], v[188:191]
    ds_read_b64_tr_b16 v[114:115], v162 offset:8704
    v_mfma_f32_16x16x32_bf16 v[208:211], v[124:127], v[96:99], v[208:211]
    ds_read_b64_tr_b16 v[116:117], v163 offset:8192
    v_mfma_f32_16x16x32_bf16 v[228:231], v[128:131], v[96:99], v[228:231]
    ds_read_b64_tr_b16 v[118:119], v163 offset:8704
    v_mfma_f32_16x16x32_bf16 v[248:251], v[132:135], v[96:99], v[248:251]
    v_mfma_f32_16x16x32_bf16 v[192:195], v[120:123], v[100:103], v[192:195]
    s_add_u32 m0, s72, 40960
    s_xor_b32 s30, s3, 8192
    buffer_load_dwordx4 v44, s[8:11], s30 offen offset:0 nt lds
    v_mfma_f32_16x16x32_bf16 v[212:215], v[124:127], v[100:103], v[212:215]
    v_mfma_f32_16x16x32_bf16 v[232:235], v[128:131], v[100:103], v[232:235]
    buffer_load_dwordx4 v45, s[8:11], s30 offen offset:1024 nt lds
    v_mfma_f32_16x16x32_bf16 v[252:255], v[132:135], v[100:103], v[252:255]
    s_waitcnt vmcnt(4)
    s_waitcnt lgkmcnt(0)
    v_mfma_f32_16x16x32_bf16 v[176:179], v[104:107], v[64:67], v[176:179]
    ds_read_b128 v[84:87], v25 offset:12288
    v_mfma_f32_16x16x32_bf16 v[196:199], v[108:111], v[64:67], v[196:199]
    v_mfma_f32_16x16x32_bf16 v[216:219], v[112:115], v[64:67], v[216:219]
    ds_read_b128 v[88:91], v25 offset:16384
    v_mfma_f32_16x16x32_bf16 v[236:239], v[116:119], v[64:67], v[236:239]
    ds_read_b128 v[92:95], v25 offset:20480
    v_mfma_f32_16x16x32_bf16 v[180:183], v[104:107], v[68:71], v[180:183]
    v_mfma_f32_16x16x32_bf16 v[200:203], v[108:111], v[68:71], v[200:203]
    ds_read_b128 v[96:99], v25 offset:24576
    v_mfma_f32_16x16x32_bf16 v[220:223], v[112:115], v[68:71], v[220:223]
    ds_read_b128 v[100:103], v25 offset:28672
    v_mfma_f32_16x16x32_bf16 v[240:243], v[116:119], v[68:71], v[240:243]
    v_mfma_f32_16x16x32_bf16 v[184:187], v[104:107], v[72:75], v[184:187]
    ds_read_b64_tr_b16 v[120:121], v160 offset:12288
    v_mfma_f32_16x16x32_bf16 v[204:207], v[108:111], v[72:75], v[204:207]
    ds_read_b64_tr_b16 v[122:123], v160 offset:12800
    v_mfma_f32_16x16x32_bf16 v[224:227], v[112:115], v[72:75], v[224:227]
    v_mfma_f32_16x16x32_bf16 v[244:247], v[116:119], v[72:75], v[244:247]
    ds_read_b64_tr_b16 v[124:125], v161 offset:12288
    v_mfma_f32_16x16x32_bf16 v[188:191], v[104:107], v[76:79], v[188:191]
    v_mfma_f32_16x16x32_bf16 v[208:211], v[108:111], v[76:79], v[208:211]
    ds_read_b64_tr_b16 v[126:127], v161 offset:12800
    v_mfma_f32_16x16x32_bf16 v[228:231], v[112:115], v[76:79], v[228:231]
    ds_read_b64_tr_b16 v[128:129], v162 offset:12288
    v_mfma_f32_16x16x32_bf16 v[248:251], v[116:119], v[76:79], v[248:251]
    v_mfma_f32_16x16x32_bf16 v[192:195], v[104:107], v[80:83], v[192:195]
    ds_read_b64_tr_b16 v[130:131], v162 offset:12800
    v_mfma_f32_16x16x32_bf16 v[212:215], v[108:111], v[80:83], v[212:215]
    ds_read_b64_tr_b16 v[132:133], v163 offset:12288
    v_mfma_f32_16x16x32_bf16 v[232:235], v[112:115], v[80:83], v[232:235]
    v_mfma_f32_16x16x32_bf16 v[252:255], v[116:119], v[80:83], v[252:255]
    ds_read_b64_tr_b16 v[134:135], v163 offset:12800
    s_waitcnt lgkmcnt(0)
    s_barrier
    v_mfma_f32_16x16x32_bf16 v[176:179], v[120:123], v[84:87], v[176:179]
    v_mfma_f32_16x16x32_bf16 v[196:199], v[124:127], v[84:87], v[196:199]
    v_mfma_f32_16x16x32_bf16 v[216:219], v[128:131], v[84:87], v[216:219]
    v_mfma_f32_16x16x32_bf16 v[236:239], v[132:135], v[84:87], v[236:239]
    v_mfma_f32_16x16x32_bf16 v[180:183], v[120:123], v[88:91], v[180:183]
    v_mfma_f32_16x16x32_bf16 v[200:203], v[124:127], v[88:91], v[200:203]
    v_mfma_f32_16x16x32_bf16 v[220:223], v[128:131], v[88:91], v[220:223]
    v_mfma_f32_16x16x32_bf16 v[240:243], v[132:135], v[88:91], v[240:243]
    v_mfma_f32_16x16x32_bf16 v[184:187], v[120:123], v[92:95], v[184:187]
    v_mfma_f32_16x16x32_bf16 v[204:207], v[124:127], v[92:95], v[204:207]
    v_mfma_f32_16x16x32_bf16 v[224:227], v[128:131], v[92:95], v[224:227]
    v_mfma_f32_16x16x32_bf16 v[244:247], v[132:135], v[92:95], v[244:247]
    v_mfma_f32_16x16x32_bf16 v[188:191], v[120:123], v[96:99], v[188:191]
    v_mfma_f32_16x16x32_bf16 v[208:211], v[124:127], v[96:99], v[208:211]
    v_mfma_f32_16x16x32_bf16 v[228:231], v[128:131], v[96:99], v[228:231]
    v_mfma_f32_16x16x32_bf16 v[248:251], v[132:135], v[96:99], v[248:251]
    v_mfma_f32_16x16x32_bf16 v[192:195], v[120:123], v[100:103], v[192:195]
    v_mfma_f32_16x16x32_bf16 v[212:215], v[124:127], v[100:103], v[212:215]
    v_mfma_f32_16x16x32_bf16 v[232:235], v[128:131], v[100:103], v[232:235]
    v_mfma_f32_16x16x32_bf16 v[252:255], v[132:135], v[100:103], v[252:255]
    s_nop 7
    s_lshl_b32 s29, s24, 13
    s_add_u32 s29, s29, 131072
    v_add_u32 v12, s29, v30
    v_add_u32 v13, s68, v30
    v_pk_mul_f32 v[176:177], v[176:177], v[6:7]
    v_pk_mul_f32 v[178:179], v[178:179], v[6:7]
    v_cvt_pk_bf16_f32 v8, v176, v177
    v_cvt_pk_bf16_f32 v9, v178, v179
    ds_write_b64 v12, v[8:9] offset:0
    v_pk_mul_f32 v[196:197], v[196:197], v[6:7]
    v_pk_mul_f32 v[198:199], v[198:199], v[6:7]
    v_cvt_pk_bf16_f32 v10, v196, v197
    v_cvt_pk_bf16_f32 v11, v198, v199
    ds_write_b64 v12, v[10:11] offset:512
    v_pk_mul_f32 v[216:217], v[216:217], v[6:7]
    v_pk_mul_f32 v[218:219], v[218:219], v[6:7]
    v_cvt_pk_bf16_f32 v8, v216, v217
    v_cvt_pk_bf16_f32 v9, v218, v219
    ds_write_b64 v12, v[8:9] offset:5120
    v_pk_mul_f32 v[236:237], v[236:237], v[6:7]
    v_pk_mul_f32 v[238:239], v[238:239], v[6:7]
    v_cvt_pk_bf16_f32 v10, v236, v237
    v_cvt_pk_bf16_f32 v11, v238, v239
    ds_write_b64 v12, v[10:11] offset:5632
    v_pk_mul_f32 v[180:181], v[180:181], v[6:7]
    v_pk_mul_f32 v[182:183], v[182:183], v[6:7]
    v_cvt_pk_bf16_f32 v8, v180, v181
    v_cvt_pk_bf16_f32 v9, v182, v183
    ds_write_b64 v12, v[8:9] offset:1024
    v_pk_mul_f32 v[200:201], v[200:201], v[6:7]
    v_pk_mul_f32 v[202:203], v[202:203], v[6:7]
    v_cvt_pk_bf16_f32 v10, v200, v201
    v_cvt_pk_bf16_f32 v11, v202, v203
    ds_write_b64 v12, v[10:11] offset:1536
    v_pk_mul_f32 v[220:221], v[220:221], v[6:7]
    v_pk_mul_f32 v[222:223], v[222:223], v[6:7]
    v_cvt_pk_bf16_f32 v8, v220, v221
    v_cvt_pk_bf16_f32 v9, v222, v223
    ds_write_b64 v12, v[8:9] offset:6144
    v_pk_mul_f32 v[240:241], v[240:241], v[6:7]
    v_pk_mul_f32 v[242:243], v[242:243], v[6:7]
    v_cvt_pk_bf16_f32 v10, v240, v241
    v_cvt_pk_bf16_f32 v11, v242, v243
    ds_write_b64 v12, v[10:11] offset:6656
    v_pk_mul_f32 v[184:185], v[184:185], v[6:7]
    v_pk_mul_f32 v[186:187], v[186:187], v[6:7]
    v_cvt_pk_bf16_f32 v8, v184, v185
    v_cvt_pk_bf16_f32 v9, v186, v187
    ds_write_b64 v12, v[8:9] offset:2048
    v_pk_mul_f32 v[204:205], v[204:205], v[6:7]
    v_pk_mul_f32 v[206:207], v[206:207], v[6:7]
    v_cvt_pk_bf16_f32 v10, v204, v205
    v_cvt_pk_bf16_f32 v11, v206, v207
    ds_write_b64 v12, v[10:11] offset:2560
    v_pk_mul_f32 v[224:225], v[224:225], v[6:7]
    v_pk_mul_f32 v[226:227], v[226:227], v[6:7]
    v_cvt_pk_bf16_f32 v8, v224, v225
    v_cvt_pk_bf16_f32 v9, v226, v227
    ds_write_b64 v12, v[8:9] offset:7168
    v_pk_mul_f32 v[244:245], v[244:245], v[6:7]
    v_pk_mul_f32 v[246:247], v[246:247], v[6:7]
    v_cvt_pk_bf16_f32 v10, v244, v245
    v_cvt_pk_bf16_f32 v11, v246, v247
    ds_write_b64 v12, v[10:11] offset:7680
    v_pk_mul_f32 v[188:189], v[188:189], v[6:7]
    v_pk_mul_f32 v[190:191], v[190:191], v[6:7]
    v_cvt_pk_bf16_f32 v8, v188, v189
    v_cvt_pk_bf16_f32 v9, v190, v191
    ds_write_b64 v12, v[8:9] offset:3072
    v_pk_mul_f32 v[208:209], v[208:209], v[6:7]
    v_pk_mul_f32 v[210:211], v[210:211], v[6:7]
    v_cvt_pk_bf16_f32 v10, v208, v209
    v_cvt_pk_bf16_f32 v11, v210, v211
    ds_write_b64 v12, v[10:11] offset:3584
    v_pk_mul_f32 v[228:229], v[228:229], v[6:7]
    v_pk_mul_f32 v[230:231], v[230:231], v[6:7]
    v_cvt_pk_bf16_f32 v8, v228, v229
    v_cvt_pk_bf16_f32 v9, v230, v231
    ds_write_b64 v13, v[8:9] offset:28672
    v_pk_mul_f32 v[248:249], v[248:249], v[6:7]
    v_pk_mul_f32 v[250:251], v[250:251], v[6:7]
    v_cvt_pk_bf16_f32 v10, v248, v249
    v_cvt_pk_bf16_f32 v11, v250, v251
    ds_write_b64 v13, v[10:11] offset:29184
    v_pk_mul_f32 v[192:193], v[192:193], v[6:7]
    v_pk_mul_f32 v[194:195], v[194:195], v[6:7]
    v_cvt_pk_bf16_f32 v8, v192, v193
    v_cvt_pk_bf16_f32 v9, v194, v195
    ds_write_b64 v12, v[8:9] offset:4096
    v_pk_mul_f32 v[212:213], v[212:213], v[6:7]
    v_pk_mul_f32 v[214:215], v[214:215], v[6:7]
    v_cvt_pk_bf16_f32 v10, v212, v213
    v_cvt_pk_bf16_f32 v11, v214, v215
    ds_write_b64 v12, v[10:11] offset:4608
    v_pk_mul_f32 v[232:233], v[232:233], v[6:7]
    v_pk_mul_f32 v[234:235], v[234:235], v[6:7]
    v_cvt_pk_bf16_f32 v8, v232, v233
    v_cvt_pk_bf16_f32 v9, v234, v235
    ds_write_b64 v13, v[8:9] offset:29696
    v_pk_mul_f32 v[252:253], v[252:253], v[6:7]
    v_pk_mul_f32 v[254:255], v[254:255], v[6:7]
    v_cvt_pk_bf16_f32 v10, v252, v253
    v_cvt_pk_bf16_f32 v11, v254, v255
    ds_write_b64 v13, v[10:11] offset:30208
    v_add_u32 v14, s68, v33
    v_xor_b32 v15, 32768, v14
    v_add_u32 v38, s29, v33
    v_xor_b32 v39, 8192, v38
    ds_read_b128 a[160:163], v38 offset:0
    ds_read_b128 a[176:179], v38 offset:1024
    ds_read_b128 a[192:195], v38 offset:2048
    ds_read_b128 a[208:211], v38 offset:3072
    ds_read_b128 a[224:227], v38 offset:4096
    ds_read_b128 a[164:167], v38 offset:5120
    ds_read_b128 a[180:183], v38 offset:6144
    ds_read_b128 a[196:199], v38 offset:7168
    ds_read_b128 a[212:215], v14 offset:28672
    ds_read_b128 a[228:231], v14 offset:29696
    v_mov_b32 v236, 0
    v_mov_b32 v237, 0
    v_mov_b32 v238, 0
    v_mov_b32 v239, 0
    v_mov_b32 v240, 0
    v_mov_b32 v241, 0
    v_mov_b32 v242, 0
    v_mov_b32 v243, 0
    v_mov_b32 v244, 0
    v_mov_b32 v245, 0
    v_mov_b32 v246, 0
    v_mov_b32 v247, 0
    v_mov_b32 v248, 0
    v_mov_b32 v249, 0
    v_mov_b32 v250, 0
    v_mov_b32 v251, 0
    v_mov_b32 v252, 0
    v_mov_b32 v253, 0
    v_mov_b32 v254, 0
    v_mov_b32 v255, 0
    v_mov_b32 v160, 0
    v_mov_b32 v161, 0
    v_mov_b32 v162, 0
    v_mov_b32 v163, 0
    v_mov_b32 v164, 0
    v_mov_b32 v165, 0
    v_mov_b32 v166, 0
    v_mov_b32 v167, 0
    v_mov_b32 v168, 0
    v_mov_b32 v169, 0
    v_mov_b32 v170, 0
    v_mov_b32 v171, 0
    v_mov_b32 v172, 0
    v_mov_b32 v173, 0
    v_mov_b32 v174, 0
    v_mov_b32 v175, 0
    v_mov_b32 v176, 0
    v_mov_b32 v177, 0
    v_mov_b32 v178, 0
    v_mov_b32 v179, 0
    v_mov_b32 v180, 0
    v_mov_b32 v181, 0
    v_mov_b32 v182, 0
    v_mov_b32 v183, 0
    v_mov_b32 v184, 0
    v_mov_b32 v185, 0
    v_mov_b32 v186, 0
    v_mov_b32 v187, 0
    v_mov_b32 v188, 0
    v_mov_b32 v189, 0
    v_mov_b32 v190, 0
    v_mov_b32 v191, 0
    v_mov_b32 v212, 0
    v_mov_b32 v213, 0
    v_mov_b32 v214, 0
    v_mov_b32 v215, 0
    s_waitcnt vmcnt(2) lgkmcnt(0)
    s_barrier
    ds_read_b128 a[168:171], v39 offset:0
    ds_read_b128 a[184:187], v39 offset:1024
    ds_read_b128 a[200:203], v39 offset:2048
    ds_read_b128 a[216:219], v39 offset:3072
    ds_read_b128 a[232:235], v39 offset:4096
    ds_read_b128 a[172:175], v39 offset:5120
    ds_read_b128 a[188:191], v39 offset:6144
    ds_read_b128 a[204:207], v39 offset:7168
    ds_read_b128 a[220:223], v15 offset:28672
    ds_read_b128 a[236:239], v15 offset:29696
    ds_read_b128 v[64:67], v46 offset:0
    ds_read_b128 v[68:71], v47 offset:0
    ds_read_b128 v[72:75], v48 offset:0
    ds_read_b128 v[76:79], v49 offset:0
    ds_read_b128 v[80:83], v46 offset:4096
    ds_read_b128 v[84:87], v47 offset:4096
    ds_read_b128 v[88:91], v48 offset:4096
    ds_read_b128 v[92:95], v49 offset:4096
    ds_read_b64_tr_b16 v[128:129], v50 offset:8192
    ds_read_b64_tr_b16 v[132:133], v51 offset:8192
    ds_read_b64_tr_b16 v[136:137], v52 offset:8192
    ds_read_b64_tr_b16 v[140:141], v53 offset:8192
    ds_read_b64_tr_b16 v[144:145], v54 offset:8192
    ds_read_b64_tr_b16 v[148:149], v55 offset:8192
    ds_read_b64_tr_b16 v[152:153], v56 offset:8192
    ds_read_b64_tr_b16 v[156:157], v57 offset:8192
    ds_read_b64_tr_b16 v[130:131], v50 offset:12288
    ds_read_b64_tr_b16 v[134:135], v51 offset:12288
    ds_read_b64_tr_b16 v[138:139], v52 offset:12288
    ds_read_b64_tr_b16 v[142:143], v53 offset:12288
    ds_read_b64_tr_b16 v[146:147], v54 offset:12288
    ds_read_b64_tr_b16 v[150:151], v55 offset:12288
    ds_read_b64_tr_b16 v[154:155], v56 offset:12288
    ds_read_b64_tr_b16 v[158:159], v57 offset:12288
    s_waitcnt lgkmcnt(0)
    s_barrier
    s_add_u32 m0, s72, 16384
    s_xor_b32 s30, s3, 16384
    buffer_load_dwordx4 v40, s[4:7], s30 offen offset:0 nt lds
    buffer_load_dwordx4 v41, s[4:7], s30 offen offset:1024 nt lds
    s_add_u32 m0, s72, 20480
    s_xor_b32 s30, s3, 20480
    buffer_load_dwordx4 v40, s[4:7], s30 offen offset:0 nt lds
    buffer_load_dwordx4 v41, s[4:7], s30 offen offset:1024 nt lds
    s_add_u32 m0, s72, 24576
    s_xor_b32 s30, s3, 16384
    buffer_load_dwordx4 v44, s[8:11], s30 offen offset:0 nt lds
    buffer_load_dwordx4 v45, s[8:11], s30 offen offset:1024 nt lds
    s_add_u32 m0, s72, 28672
    s_xor_b32 s30, s3, 20480
    buffer_load_dwordx4 v44, s[8:11], s30 offen offset:0 nt lds
    buffer_load_dwordx4 v45, s[8:11], s30 offen offset:1024 nt lds
    s_add_u32 m0, s72, 49152
    s_xor_b32 s30, s3, 24576
    buffer_load_dwordx4 v40, s[4:7], s30 offen offset:0 nt lds
    buffer_load_dwordx4 v41, s[4:7], s30 offen offset:1024 nt lds
    s_add_u32 m0, s72, 53248
    s_xor_b32 s30, s3, 28672
    buffer_load_dwordx4 v40, s[4:7], s30 offen offset:0 nt lds
    buffer_load_dwordx4 v41, s[4:7], s30 offen offset:1024 nt lds
    s_add_u32 m0, s72, 57344
    s_xor_b32 s30, s3, 24576
    buffer_load_dwordx4 v44, s[8:11], s30 offen offset:0 nt lds
    buffer_load_dwordx4 v45, s[8:11], s30 offen offset:1024 nt lds
    s_add_u32 m0, s72, 61440
    s_xor_b32 s30, s3, 28672
    buffer_load_dwordx4 v44, s[8:11], s30 offen offset:0 nt lds
    buffer_load_dwordx4 v45, s[8:11], s30 offen offset:1024 nt lds
L_mref:
    v_mfma_f32_16x16x32_bf16 v[216:219], v[64:67], a[160:163], 0
    v_mfma_f32_16x16x32_bf16 v[220:223], v[64:67], a[176:179], 0
    v_mfma_f32_16x16x32_bf16 v[224:227], v[64:67], a[192:195], 0
    v_mfma_f32_16x16x32_bf16 v[228:231], v[64:67], a[208:211], 0
    v_mfma_f32_16x16x32_bf16 v[232:235], v[64:67], a[224:227], 0
    v_mfma_f32_16x16x32_bf16 v[216:219], v[68:71], a[164:167], v[216:219]
    v_mfma_f32_16x16x32_bf16 v[220:223], v[68:71], a[180:183], v[220:223]
    v_mfma_f32_16x16x32_bf16 v[224:227], v[68:71], a[196:199], v[224:227]
    v_mfma_f32_16x16x32_bf16 v[228:231], v[68:71], a[212:215], v[228:231]
    v_mfma_f32_16x16x32_bf16 v[232:235], v[68:71], a[228:231], v[232:235]
    v_mfma_f32_16x16x32_bf16 v[216:219], v[72:75], a[168:171], v[216:219]
    v_mfma_f32_16x16x32_bf16 v[220:223], v[72:75], a[184:187], v[220:223]
    v_mfma_f32_16x16x32_bf16 v[224:227], v[72:75], a[200:203], v[224:227]
    v_mfma_f32_16x16x32_bf16 v[228:231], v[72:75], a[216:219], v[228:231]
    v_mfma_f32_16x16x32_bf16 v[232:235], v[72:75], a[232:235], v[232:235]
    v_mfma_f32_16x16x32_bf16 v[216:219], v[76:79], a[172:175], v[216:219]
    v_mfma_f32_16x16x32_bf16 v[220:223], v[76:79], a[188:191], v[220:223]
    v_mfma_f32_16x16x32_bf16 v[224:227], v[76:79], a[204:207], v[224:227]
    v_mfma_f32_16x16x32_bf16 v[228:231], v[76:79], a[220:223], v[228:231]
    v_mfma_f32_16x16x32_bf16 v[232:235], v[76:79], a[236:239], v[232:235]
    s_nop 7
    v_max3_f32 v216, v216, v217, v218
    v_max_f32 v216, v216, v219
    v_mov_b32 v217, v216
    v_max3_f32 v220, v220, v221, v222
    v_max_f32 v220, v220, v223
    v_mov_b32 v221, v220
    v_max3_f32 v224, v224, v225, v226
    v_max_f32 v224, v224, v227
    v_mov_b32 v225, v224
    v_max3_f32 v228, v228, v229, v230
    v_max_f32 v228, v228, v231
    v_mov_b32 v229, v228
    v_max3_f32 v232, v232, v233, v234
    v_max_f32 v232, v232, v235
    v_mov_b32 v233, v232
    s_nop 1
    v_permlane32_swap_b32 v216, v217
    v_permlane32_swap_b32 v220, v221
    v_permlane32_swap_b32 v224, v225
    v_permlane32_swap_b32 v228, v229
    v_permlane32_swap_b32 v232, v233
    s_nop 1
    v_max_f32 v216, v216, v217
    v_mov_b32 v217, v216
    v_max_f32 v220, v220, v221
    v_mov_b32 v221, v220
    v_max_f32 v224, v224, v225
    v_mov_b32 v225, v224
    v_max_f32 v228, v228, v229
    v_mov_b32 v229, v228
    v_max_f32 v232, v232, v233
    v_mov_b32 v233, v232
    s_nop 1
    v_permlane16_swap_b32 v216, v217
    v_permlane16_swap_b32 v220, v221
    v_permlane16_swap_b32 v224, v225
    v_permlane16_swap_b32 v228, v229
    v_permlane16_swap_b32 v232, v233
    s_nop 1
    v_max_f32 v216, v216, v217
    v_sub_f32 v216, 0, v216
    v_mov_b32 v217, v216
    v_mov_b32 v218, v216
    v_mov_b32 v219, v216
    v_max_f32 v220, v220, v221
    v_sub_f32 v220, 0, v220
    v_mov_b32 v221, v220
    v_mov_b32 v222, v220
    v_mov_b32 v223, v220
    v_max_f32 v224, v224, v225
    v_sub_f32 v224, 0, v224
    v_mov_b32 v225, v224
    v_mov_b32 v226, v224
    v_mov_b32 v227, v224
    v_max_f32 v228, v228, v229
    v_sub_f32 v228, 0, v228
    v_mov_b32 v229, v228
    v_mov_b32 v230, v228
    v_mov_b32 v231, v228
    v_max_f32 v232, v232, v233
    v_sub_f32 v232, 0, v232
    v_mov_b32 v233, v232
    v_mov_b32 v234, v232
    v_mov_b32 v235, v232
    s_nop 1
    v_mfma_f32_16x16x32_bf16 v[192:195], v[64:67], a[160:163], v[216:219]
    v_mfma_f32_16x16x32_bf16 v[196:199], v[80:83], a[160:163], v[216:219]
    v_mfma_f32_16x16x32_bf16 v[192:195], v[68:71], a[164:167], v[192:195]
    v_mfma_f32_16x16x32_bf16 v[196:199], v[84:87], a[164:167], v[196:199]
    v_mfma_f32_16x16x32_bf16 v[192:195], v[72:75], a[168:171], v[192:195]
    v_mfma_f32_16x16x32_bf16 v[196:199], v[88:91], a[168:171], v[196:199]
    v_mfma_f32_16x16x32_bf16 v[192:195], v[76:79], a[172:175], v[192:195]
    v_mfma_f32_16x16x32_bf16 v[196:199], v[92:95], a[172:175], v[196:199]
    s_mov_b32 s28, 8
    s_cmp_eq_u32 s64, 0
    s_cselect_b32 s29, 4, 2
    s_lshl_b32 s99, s29, 13
    s_xor_b32 s26, s99, s3
    s_add_u32 s27, s26, 4096
    s_cmp_eq_u32 s64, 0
    s_nop 2
    s_cbranch_scc1 L_loopA
L_loopB:
    v_mfma_f32_16x16x32_bf16 v[200:203], v[64:67], a[176:179], v[220:223]
    v_exp_f32 v192, v192
    v_mfma_f32_16x16x32_bf16 v[204:207], v[80:83], a[176:179], v[220:223]
    s_waitcnt vmcnt(12)
    v_mfma_f32_16x16x32_bf16 v[200:203], v[68:71], a[180:183], v[200:203]
    v_exp_f32 v193, v193
    v_mfma_f32_16x16x32_bf16 v[204:207], v[84:87], a[180:183], v[204:207]
    ds_read_b128 v[96:99], v46 offset:0
    v_mfma_f32_16x16x32_bf16 v[200:203], v[72:75], a[184:187], v[200:203]
    v_exp_f32 v194, v194
    v_mfma_f32_16x16x32_bf16 v[204:207], v[88:91], a[184:187], v[204:207]
    v_cvt_pk_bf16_f32 v208, v192, v193
    v_mfma_f32_16x16x32_bf16 v[200:203], v[76:79], a[188:191], v[200:203]
    ds_read_b128 v[100:103], v47 offset:0
    v_mfma_f32_16x16x32_bf16 v[204:207], v[92:95], a[188:191], v[204:207]
    v_exp_f32 v195, v195
    v_mfma_f32_16x16x32_bf16 a[16:19], v[160:163], v[212:215], a[16:19]
    v_exp_f32 v196, v196
    v_mfma_f32_16x16x32_bf16 a[36:39], v[164:167], v[212:215], a[36:39]
    v_cvt_pk_bf16_f32 v209, v194, v195
    v_mfma_f32_16x16x32_bf16 a[56:59], v[168:171], v[212:215], a[56:59]
    ds_read_b128 v[104:107], v48 offset:0
    v_mfma_f32_16x16x32_bf16 a[76:79], v[172:175], v[212:215], a[76:79]
    v_exp_f32 v197, v197
    v_mfma_f32_16x16x32_bf16 a[96:99], v[176:179], v[212:215], a[96:99]
    v_exp_f32 v198, v198
    v_mfma_f32_16x16x32_bf16 a[116:119], v[180:183], v[212:215], a[116:119]
    ds_read_b128 v[108:111], v49 offset:0
    v_mfma_f32_16x16x32_bf16 a[136:139], v[184:187], v[212:215], a[136:139]
    v_cvt_pk_bf16_f32 v210, v196, v197
    v_mfma_f32_16x16x32_bf16 a[156:159], v[188:191], v[212:215], a[156:159]
    v_exp_f32 v199, v199
    v_mfma_f32_16x16x32_bf16 v[252:255], v[60:63], v[212:215], v[252:255]
    s_nop 0
    v_cvt_pk_bf16_f32 v211, v198, v199
    v_mfma_f32_16x16x32_bf16 v[192:195], v[64:67], a[192:195], v[224:227]
    v_exp_f32 v200, v200
    v_mfma_f32_16x16x32_bf16 v[196:199], v[80:83], a[192:195], v[224:227]
    s_add_u32 m0, s68, 0
    s_waitcnt lgkmcnt(0)
    v_mfma_f32_16x16x32_bf16 v[192:195], v[68:71], a[196:199], v[192:195]
    buffer_load_dwordx4 v40, s[4:7], s26 offen offset:0 nt lds
    v_mfma_f32_16x16x32_bf16 v[196:199], v[84:87], a[196:199], v[196:199]
    v_exp_f32 v201, v201
    v_mfma_f32_16x16x32_bf16 v[192:195], v[72:75], a[200:203], v[192:195]
    v_exp_f32 v202, v202
    v_mfma_f32_16x16x32_bf16 v[196:199], v[88:91], a[200:203], v[196:199]
    buffer_load_dwordx4 v41, s[4:7], s26 offen offset:1024 nt lds
    v_cvt_pk_bf16_f32 v212, v200, v201
    v_mfma_f32_16x16x32_bf16 v[192:195], v[76:79], a[204:207], v[192:195]
    v_exp_f32 v203, v203
    v_mfma_f32_16x16x32_bf16 v[196:199], v[92:95], a[204:207], v[196:199]
    buffer_load_dwordx4 v42, s[4:7], s26 offen offset:2048 nt lds
    v_mfma_f32_16x16x32_bf16 a[0:3], v[128:131], v[208:211], a[0:3]
    v_exp_f32 v204, v204
    v_mfma_f32_16x16x32_bf16 a[20:23], v[132:135], v[208:211], a[20:23]
    buffer_load_dwordx4 v43, s[4:7], s26 offen offset:3072 nt lds
    v_mfma_f32_16x16x32_bf16 a[40:43], v[136:139], v[208:211], a[40:43]
    v_cvt_pk_bf16_f32 v213, v202, v203
    v_mfma_f32_16x16x32_bf16 a[60:63], v[140:143], v[208:211], a[60:63]
    v_exp_f32 v205, v205
    s_waitcnt vmcnt(12)
    v_mfma_f32_16x16x32_bf16 a[80:83], v[144:147], v[208:211], a[80:83]
    v_exp_f32 v206, v206
    v_mfma_f32_16x16x32_bf16 a[100:103], v[148:151], v[208:211], a[100:103]
    ds_read_b128 v[112:115], v46 offset:4096
    ds_read_b128 v[116:119], v47 offset:4096
    v_mfma_f32_16x16x32_bf16 a[120:123], v[152:155], v[208:211], a[120:123]
    v_cvt_pk_bf16_f32 v214, v204, v205
    v_exp_f32 v207, v207
    v_mfma_f32_16x16x32_bf16 a[140:143], v[156:159], v[208:211], a[140:143]
    ds_read_b128 v[120:123], v48 offset:4096
    v_mfma_f32_16x16x32_bf16 v[236:239], v[60:63], v[208:211], v[236:239]
    ds_read_b128 v[124:127], v49 offset:4096
    s_nop 0
    v_cvt_pk_bf16_f32 v215, v206, v207
    v_mfma_f32_16x16x32_bf16 v[200:203], v[64:67], a[208:211], v[228:231]
    v_exp_f32 v192, v192
    v_mfma_f32_16x16x32_bf16 v[204:207], v[80:83], a[208:211], v[228:231]
    s_add_u32 m0, s68, 4096
    s_waitcnt lgkmcnt(0)
    buffer_load_dwordx4 v40, s[4:7], s27 offen offset:0 nt lds
    v_mfma_f32_16x16x32_bf16 v[200:203], v[68:71], a[212:215], v[200:203]
    v_exp_f32 v193, v193
    v_mfma_f32_16x16x32_bf16 v[204:207], v[84:87], a[212:215], v[204:207]
    buffer_load_dwordx4 v41, s[4:7], s27 offen offset:1024 nt lds
    v_mfma_f32_16x16x32_bf16 v[200:203], v[72:75], a[216:219], v[200:203]
    v_exp_f32 v194, v194
    v_mfma_f32_16x16x32_bf16 v[204:207], v[88:91], a[216:219], v[204:207]
    buffer_load_dwordx4 v42, s[4:7], s27 offen offset:2048 nt lds
    v_mfma_f32_16x16x32_bf16 v[200:203], v[76:79], a[220:223], v[200:203]
    v_cvt_pk_bf16_f32 v208, v192, v193
    v_exp_f32 v195, v195
    v_mfma_f32_16x16x32_bf16 v[204:207], v[92:95], a[220:223], v[204:207]
    buffer_load_dwordx4 v43, s[4:7], s27 offen offset:3072 nt lds
    v_mfma_f32_16x16x32_bf16 a[4:7], v[128:131], v[212:215], a[4:7]
    v_exp_f32 v196, v196
    v_mfma_f32_16x16x32_bf16 a[24:27], v[132:135], v[212:215], a[24:27]
    s_waitcnt vmcnt(12)
    ds_read_b64_tr_b16 v[160:161], v50 offset:8192
    v_cvt_pk_bf16_f32 v209, v194, v195
    v_mfma_f32_16x16x32_bf16 a[44:47], v[136:139], v[212:215], a[44:47]
    v_exp_f32 v197, v197
    v_mfma_f32_16x16x32_bf16 a[64:67], v[140:143], v[212:215], a[64:67]
    ds_read_b64_tr_b16 v[164:165], v51 offset:8192
    ds_read_b64_tr_b16 v[168:169], v52 offset:8192
    v_mfma_f32_16x16x32_bf16 a[84:87], v[144:147], v[212:215], a[84:87]
    v_exp_f32 v198, v198
    v_mfma_f32_16x16x32_bf16 a[104:107], v[148:151], v[212:215], a[104:107]
    ds_read_b64_tr_b16 v[172:173], v53 offset:8192
    ds_read_b64_tr_b16 v[176:177], v54 offset:8192
    v_mfma_f32_16x16x32_bf16 a[124:127], v[152:155], v[212:215], a[124:127]
    v_cvt_pk_bf16_f32 v210, v196, v197
    ds_read_b64_tr_b16 v[180:181], v55 offset:8192
    v_mfma_f32_16x16x32_bf16 a[144:147], v[156:159], v[212:215], a[144:147]
    v_exp_f32 v199, v199
    ds_read_b64_tr_b16 v[184:185], v56 offset:8192
    v_mfma_f32_16x16x32_bf16 v[240:243], v[60:63], v[212:215], v[240:243]
    ds_read_b64_tr_b16 v[188:189], v57 offset:8192
    s_nop 0
    v_cvt_pk_bf16_f32 v211, v198, v199
    v_mfma_f32_16x16x32_bf16 v[192:195], v[64:67], a[224:227], v[232:235]
    v_exp_f32 v200, v200
    v_mfma_f32_16x16x32_bf16 v[196:199], v[80:83], a[224:227], v[232:235]
    s_add_u32 m0, s68, 8192
    s_waitcnt lgkmcnt(0)
    buffer_load_dwordx4 v44, s[8:11], s26 offen offset:0 nt lds
    v_mfma_f32_16x16x32_bf16 v[192:195], v[68:71], a[228:231], v[192:195]
    v_exp_f32 v201, v201
    v_mfma_f32_16x16x32_bf16 v[196:199], v[84:87], a[228:231], v[196:199]
    buffer_load_dwordx4 v45, s[8:11], s26 offen offset:1024 nt lds
    v_mfma_f32_16x16x32_bf16 v[192:195], v[72:75], a[232:235], v[192:195]
    v_exp_f32 v202, v202
    v_mfma_f32_16x16x32_bf16 v[196:199], v[88:91], a[232:235], v[196:199]
    buffer_load_dwordx4 v44, s[8:11], s26 offen offset:2048 nt lds
    v_mfma_f32_16x16x32_bf16 v[192:195], v[76:79], a[236:239], v[192:195]
    v_cvt_pk_bf16_f32 v212, v200, v201
    v_exp_f32 v203, v203
    v_mfma_f32_16x16x32_bf16 v[196:199], v[92:95], a[236:239], v[196:199]
    buffer_load_dwordx4 v45, s[8:11], s26 offen offset:3072 nt lds
    v_mfma_f32_16x16x32_bf16 a[8:11], v[128:131], v[208:211], a[8:11]
    v_exp_f32 v204, v204
    v_mfma_f32_16x16x32_bf16 a[28:31], v[132:135], v[208:211], a[28:31]
    s_waitcnt vmcnt(12)
    ds_read_b64_tr_b16 v[162:163], v50 offset:12288
    v_cvt_pk_bf16_f32 v213, v202, v203
    v_mfma_f32_16x16x32_bf16 a[48:51], v[136:139], v[208:211], a[48:51]
    v_exp_f32 v205, v205
    v_mfma_f32_16x16x32_bf16 a[68:71], v[140:143], v[208:211], a[68:71]
    ds_read_b64_tr_b16 v[166:167], v51 offset:12288
    ds_read_b64_tr_b16 v[170:171], v52 offset:12288
    v_mfma_f32_16x16x32_bf16 a[88:91], v[144:147], v[208:211], a[88:91]
    v_exp_f32 v206, v206
    v_mfma_f32_16x16x32_bf16 a[108:111], v[148:151], v[208:211], a[108:111]
    ds_read_b64_tr_b16 v[174:175], v53 offset:12288
    ds_read_b64_tr_b16 v[178:179], v54 offset:12288
    v_mfma_f32_16x16x32_bf16 a[128:131], v[152:155], v[208:211], a[128:131]
    v_cvt_pk_bf16_f32 v214, v204, v205
    ds_read_b64_tr_b16 v[182:183], v55 offset:12288
    v_mfma_f32_16x16x32_bf16 a[148:151], v[156:159], v[208:211], a[148:151]
    v_exp_f32 v207, v207
    ds_read_b64_tr_b16 v[186:187], v56 offset:12288
    v_mfma_f32_16x16x32_bf16 v[244:247], v[60:63], v[208:211], v[244:247]
    ds_read_b64_tr_b16 v[190:191], v57 offset:12288
    s_nop 0
    v_cvt_pk_bf16_f32 v215, v206, v207
    v_mfma_f32_16x16x32_bf16 v[200:203], v[96:99], a[160:163], v[216:219]
    v_exp_f32 v192, v192
    v_mfma_f32_16x16x32_bf16 v[204:207], v[112:115], a[160:163], v[216:219]
    s_add_u32 m0, s68, 12288
    s_waitcnt lgkmcnt(0)
    v_mfma_f32_16x16x32_bf16 v[200:203], v[100:103], a[164:167], v[200:203]
    v_exp_f32 v193, v193
    v_mfma_f32_16x16x32_bf16 v[204:207], v[116:119], a[164:167], v[204:207]
    buffer_load_dwordx4 v44, s[8:11], s27 offen offset:0 nt lds
    v_mfma_f32_16x16x32_bf16 v[200:203], v[104:107], a[168:171], v[200:203]
    v_exp_f32 v194, v194
    v_mfma_f32_16x16x32_bf16 v[204:207], v[120:123], a[168:171], v[204:207]
    v_cvt_pk_bf16_f32 v208, v192, v193
    v_mfma_f32_16x16x32_bf16 v[200:203], v[108:111], a[172:175], v[200:203]
    buffer_load_dwordx4 v45, s[8:11], s27 offen offset:1024 nt lds
    v_mfma_f32_16x16x32_bf16 v[204:207], v[124:127], a[172:175], v[204:207]
    v_exp_f32 v195, v195
    v_mfma_f32_16x16x32_bf16 a[12:15], v[128:131], v[212:215], a[12:15]
    v_exp_f32 v196, v196
    v_mfma_f32_16x16x32_bf16 a[32:35], v[132:135], v[212:215], a[32:35]
    buffer_load_dwordx4 v44, s[8:11], s27 offen offset:2048 nt lds
    v_mfma_f32_16x16x32_bf16 a[52:55], v[136:139], v[212:215], a[52:55]
    v_cvt_pk_bf16_f32 v209, v194, v195
    v_mfma_f32_16x16x32_bf16 a[72:75], v[140:143], v[212:215], a[72:75]
    v_exp_f32 v197, v197
    v_mfma_f32_16x16x32_bf16 a[92:95], v[144:147], v[212:215], a[92:95]
    v_exp_f32 v198, v198
    v_mfma_f32_16x16x32_bf16 a[112:115], v[148:151], v[212:215], a[112:115]
    buffer_load_dwordx4 v45, s[8:11], s27 offen offset:3072 nt lds
    v_mfma_f32_16x16x32_bf16 a[132:135], v[152:155], v[212:215], a[132:135]
    v_cvt_pk_bf16_f32 v210, v196, v197
    v_mfma_f32_16x16x32_bf16 a[152:155], v[156:159], v[212:215], a[152:155]
    v_exp_f32 v199, v199
    v_mfma_f32_16x16x32_bf16 v[248:251], v[60:63], v[212:215], v[248:251]
    s_add_u32 s99, s99, 8192
    s_xor_b32 s26, s99, s3
    s_add_u32 s27, s26, 4096
    s_nop 0
    v_cvt_pk_bf16_f32 v211, v198, v199
    v_mfma_f32_16x16x32_bf16 v[192:195], v[96:99], a[176:179], v[220:223]
    v_exp_f32 v200, v200
    v_mfma_f32_16x16x32_bf16 v[196:199], v[112:115], a[176:179], v[220:223]
    s_waitcnt vmcnt(12)
    v_mfma_f32_16x16x32_bf16 v[192:195], v[100:103], a[180:183], v[192:195]
    v_exp_f32 v201, v201
    v_mfma_f32_16x16x32_bf16 v[196:199], v[116:119], a[180:183], v[196:199]
    ds_read_b128 v[64:67], v46 offset:0
    v_mfma_f32_16x16x32_bf16 v[192:195], v[104:107], a[184:187], v[192:195]
    v_exp_f32 v202, v202
    v_mfma_f32_16x16x32_bf16 v[196:199], v[120:123], a[184:187], v[196:199]
    v_cvt_pk_bf16_f32 v212, v200, v201
    v_mfma_f32_16x16x32_bf16 v[192:195], v[108:111], a[188:191], v[192:195]
    ds_read_b128 v[68:71], v47 offset:0
    v_mfma_f32_16x16x32_bf16 v[196:199], v[124:127], a[188:191], v[196:199]
    v_exp_f32 v203, v203
    v_mfma_f32_16x16x32_bf16 a[16:19], v[128:131], v[208:211], a[16:19]
    v_exp_f32 v204, v204
    v_mfma_f32_16x16x32_bf16 a[36:39], v[132:135], v[208:211], a[36:39]
    v_cvt_pk_bf16_f32 v213, v202, v203
    v_mfma_f32_16x16x32_bf16 a[56:59], v[136:139], v[208:211], a[56:59]
    ds_read_b128 v[72:75], v48 offset:0
    v_mfma_f32_16x16x32_bf16 a[76:79], v[140:143], v[208:211], a[76:79]
    v_exp_f32 v205, v205
    v_mfma_f32_16x16x32_bf16 a[96:99], v[144:147], v[208:211], a[96:99]
    v_exp_f32 v206, v206
    v_mfma_f32_16x16x32_bf16 a[116:119], v[148:151], v[208:211], a[116:119]
    ds_read_b128 v[76:79], v49 offset:0
    v_mfma_f32_16x16x32_bf16 a[136:139], v[152:155], v[208:211], a[136:139]
    v_cvt_pk_bf16_f32 v214, v204, v205
    v_mfma_f32_16x16x32_bf16 a[156:159], v[156:159], v[208:211], a[156:159]
    v_exp_f32 v207, v207
    v_mfma_f32_16x16x32_bf16 v[252:255], v[60:63], v[208:211], v[252:255]
    s_nop 0
    v_cvt_pk_bf16_f32 v215, v206, v207
    v_mfma_f32_16x16x32_bf16 v[200:203], v[96:99], a[192:195], v[224:227]
    v_exp_f32 v192, v192
    v_mfma_f32_16x16x32_bf16 v[204:207], v[112:115], a[192:195], v[224:227]
    s_add_u32 m0, s68, 0
    s_waitcnt lgkmcnt(0)
    v_mfma_f32_16x16x32_bf16 v[200:203], v[100:103], a[196:199], v[200:203]
    buffer_load_dwordx4 v40, s[4:7], s26 offen offset:0 nt lds
    v_mfma_f32_16x16x32_bf16 v[204:207], v[116:119], a[196:199], v[204:207]
    v_exp_f32 v193, v193
    v_mfma_f32_16x16x32_bf16 v[200:203], v[104:107], a[200:203], v[200:203]
    v_exp_f32 v194, v194
    v_mfma_f32_16x16x32_bf16 v[204:207], v[120:123], a[200:203], v[204:207]
    buffer_load_dwordx4 v41, s[4:7], s26 offen offset:1024 nt lds
    v_cvt_pk_bf16_f32 v208, v192, v193
    v_mfma_f32_16x16x32_bf16 v[200:203], v[108:111], a[204:207], v[200:203]
    v_exp_f32 v195, v195
    v_mfma_f32_16x16x32_bf16 v[204:207], v[124:127], a[204:207], v[204:207]
    buffer_load_dwordx4 v42, s[4:7], s26 offen offset:2048 nt lds
    v_mfma_f32_16x16x32_bf16 a[0:3], v[160:163], v[212:215], a[0:3]
    v_exp_f32 v196, v196
    v_mfma_f32_16x16x32_bf16 a[20:23], v[164:167], v[212:215], a[20:23]
    buffer_load_dwordx4 v43, s[4:7], s26 offen offset:3072 nt lds
    v_mfma_f32_16x16x32_bf16 a[40:43], v[168:171], v[212:215], a[40:43]
    v_cvt_pk_bf16_f32 v209, v194, v195
    v_mfma_f32_16x16x32_bf16 a[60:63], v[172:175], v[212:215], a[60:63]
    v_exp_f32 v197, v197
    s_waitcnt vmcnt(12)
    v_mfma_f32_16x16x32_bf16 a[80:83], v[176:179], v[212:215], a[80:83]
    v_exp_f32 v198, v198
    v_mfma_f32_16x16x32_bf16 a[100:103], v[180:183], v[212:215], a[100:103]
    ds_read_b128 v[80:83], v46 offset:4096
    ds_read_b128 v[84:87], v47 offset:4096
    v_mfma_f32_16x16x32_bf16 a[120:123], v[184:187], v[212:215], a[120:123]
    v_cvt_pk_bf16_f32 v210, v196, v197
    v_exp_f32 v199, v199
    v_mfma_f32_16x16x32_bf16 a[140:143], v[188:191], v[212:215], a[140:143]
    ds_read_b128 v[88:91], v48 offset:4096
    v_mfma_f32_16x16x32_bf16 v[236:239], v[60:63], v[212:215], v[236:239]
    ds_read_b128 v[92:95], v49 offset:4096
    s_nop 0
    v_cvt_pk_bf16_f32 v211, v198, v199
    v_mfma_f32_16x16x32_bf16 v[192:195], v[96:99], a[208:211], v[228:231]
    v_exp_f32 v200, v200
    v_mfma_f32_16x16x32_bf16 v[196:199], v[112:115], a[208:211], v[228:231]
    s_add_u32 m0, s68, 4096
    s_waitcnt lgkmcnt(0)
    buffer_load_dwordx4 v40, s[4:7], s27 offen offset:0 nt lds
    v_mfma_f32_16x16x32_bf16 v[192:195], v[100:103], a[212:215], v[192:195]
    v_exp_f32 v201, v201
    v_mfma_f32_16x16x32_bf16 v[196:199], v[116:119], a[212:215], v[196:199]
    buffer_load_dwordx4 v41, s[4:7], s27 offen offset:1024 nt lds
    v_mfma_f32_16x16x32_bf16 v[192:195], v[104:107], a[216:219], v[192:195]
    v_exp_f32 v202, v202
    v_mfma_f32_16x16x32_bf16 v[196:199], v[120:123], a[216:219], v[196:199]
    buffer_load_dwordx4 v42, s[4:7], s27 offen offset:2048 nt lds
    v_mfma_f32_16x16x32_bf16 v[192:195], v[108:111], a[220:223], v[192:195]
    v_cvt_pk_bf16_f32 v212, v200, v201
    v_exp_f32 v203, v203
    v_mfma_f32_16x16x32_bf16 v[196:199], v[124:127], a[220:223], v[196:199]
    buffer_load_dwordx4 v43, s[4:7], s27 offen offset:3072 nt lds
    v_mfma_f32_16x16x32_bf16 a[4:7], v[160:163], v[208:211], a[4:7]
    v_exp_f32 v204, v204
    v_mfma_f32_16x16x32_bf16 a[24:27], v[164:167], v[208:211], a[24:27]
    s_waitcnt vmcnt(12)
    ds_read_b64_tr_b16 v[128:129], v50 offset:8192
    v_cvt_pk_bf16_f32 v213, v202, v203
    v_mfma_f32_16x16x32_bf16 a[44:47], v[168:171], v[208:211], a[44:47]
    v_exp_f32 v205, v205
    v_mfma_f32_16x16x32_bf16 a[64:67], v[172:175], v[208:211], a[64:67]
    ds_read_b64_tr_b16 v[132:133], v51 offset:8192
    ds_read_b64_tr_b16 v[136:137], v52 offset:8192
    v_mfma_f32_16x16x32_bf16 a[84:87], v[176:179], v[208:211], a[84:87]
    v_exp_f32 v206, v206
    v_mfma_f32_16x16x32_bf16 a[104:107], v[180:183], v[208:211], a[104:107]
    ds_read_b64_tr_b16 v[140:141], v53 offset:8192
    ds_read_b64_tr_b16 v[144:145], v54 offset:8192
    v_mfma_f32_16x16x32_bf16 a[124:127], v[184:187], v[208:211], a[124:127]
    v_cvt_pk_bf16_f32 v214, v204, v205
    ds_read_b64_tr_b16 v[148:149], v55 offset:8192
    v_mfma_f32_16x16x32_bf16 a[144:147], v[188:191], v[208:211], a[144:147]
    v_exp_f32 v207, v207
    ds_read_b64_tr_b16 v[152:153], v56 offset:8192
    v_mfma_f32_16x16x32_bf16 v[240:243], v[60:63], v[208:211], v[240:243]
    ds_read_b64_tr_b16 v[156:157], v57 offset:8192
    s_nop 0
    v_cvt_pk_bf16_f32 v215, v206, v207
    v_mfma_f32_16x16x32_bf16 v[200:203], v[96:99], a[224:227], v[232:235]
    v_exp_f32 v192, v192
    v_mfma_f32_16x16x32_bf16 v[204:207], v[112:115], a[224:227], v[232:235]
    s_add_u32 m0, s68, 8192
    s_waitcnt lgkmcnt(0)
    buffer_load_dwordx4 v44, s[8:11], s26 offen offset:0 nt lds
    v_mfma_f32_16x16x32_bf16 v[200:203], v[100:103], a[228:231], v[200:203]
    v_exp_f32 v193, v193
    v_mfma_f32_16x16x32_bf16 v[204:207], v[116:119], a[228:231], v[204:207]
    buffer_load_dwordx4 v45, s[8:11], s26 offen offset:1024 nt lds
    v_mfma_f32_16x16x32_bf16 v[200:203], v[104:107], a[232:235], v[200:203]
    v_exp_f32 v194, v194
    v_mfma_f32_16x16x32_bf16 v[204:207], v[120:123], a[232:235], v[204:207]
    buffer_load_dwordx4 v44, s[8:11], s26 offen offset:2048 nt lds
    v_mfma_f32_16x16x32_bf16 v[200:203], v[108:111], a[236:239], v[200:203]
    v_cvt_pk_bf16_f32 v208, v192, v193
    v_exp_f32 v195, v195
    v_mfma_f32_16x16x32_bf16 v[204:207], v[124:127], a[236:239], v[204:207]
    buffer_load_dwordx4 v45, s[8:11], s26 offen offset:3072 nt lds
    v_mfma_f32_16x16x32_bf16 a[8:11], v[160:163], v[212:215], a[8:11]
    v_exp_f32 v196, v196
    v_mfma_f32_16x16x32_bf16 a[28:31], v[164:167], v[212:215], a[28:31]
    s_waitcnt vmcnt(12)
    ds_read_b64_tr_b16 v[130:131], v50 offset:12288
    v_cvt_pk_bf16_f32 v209, v194, v195
    v_mfma_f32_16x16x32_bf16 a[48:51], v[168:171], v[212:215], a[48:51]
    v_exp_f32 v197, v197
    v_mfma_f32_16x16x32_bf16 a[68:71], v[172:175], v[212:215], a[68:71]
    ds_read_b64_tr_b16 v[134:135], v51 offset:12288
    ds_read_b64_tr_b16 v[138:139], v52 offset:12288
    v_mfma_f32_16x16x32_bf16 a[88:91], v[176:179], v[212:215], a[88:91]
    v_exp_f32 v198, v198
    v_mfma_f32_16x16x32_bf16 a[108:111], v[180:183], v[212:215], a[108:111]
    ds_read_b64_tr_b16 v[142:143], v53 offset:12288
    ds_read_b64_tr_b16 v[146:147], v54 offset:12288
    v_mfma_f32_16x16x32_bf16 a[128:131], v[184:187], v[212:215], a[128:131]
    v_cvt_pk_bf16_f32 v210, v196, v197
    ds_read_b64_tr_b16 v[150:151], v55 offset:12288
    v_mfma_f32_16x16x32_bf16 a[148:151], v[188:191], v[212:215], a[148:151]
    v_exp_f32 v199, v199
    ds_read_b64_tr_b16 v[154:155], v56 offset:12288
    v_mfma_f32_16x16x32_bf16 v[244:247], v[60:63], v[212:215], v[244:247]
    ds_read_b64_tr_b16 v[158:159], v57 offset:12288
    s_nop 0
    v_cvt_pk_bf16_f32 v211, v198, v199
    v_mfma_f32_16x16x32_bf16 v[192:195], v[64:67], a[160:163], v[216:219]
    v_exp_f32 v200, v200
    v_mfma_f32_16x16x32_bf16 v[196:199], v[80:83], a[160:163], v[216:219]
    s_add_u32 m0, s68, 12288
    s_waitcnt lgkmcnt(0)
    v_mfma_f32_16x16x32_bf16 v[192:195], v[68:71], a[164:167], v[192:195]
    v_exp_f32 v201, v201
    v_mfma_f32_16x16x32_bf16 v[196:199], v[84:87], a[164:167], v[196:199]
    buffer_load_dwordx4 v44, s[8:11], s27 offen offset:0 nt lds
    v_mfma_f32_16x16x32_bf16 v[192:195], v[72:75], a[168:171], v[192:195]
    v_exp_f32 v202, v202
    v_mfma_f32_16x16x32_bf16 v[196:199], v[88:91], a[168:171], v[196:199]
    v_cvt_pk_bf16_f32 v212, v200, v201
    v_mfma_f32_16x16x32_bf16 v[192:195], v[76:79], a[172:175], v[192:195]
    buffer_load_dwordx4 v45, s[8:11], s27 offen offset:1024 nt lds
    v_mfma_f32_16x16x32_bf16 v[196:199], v[92:95], a[172:175], v[196:199]
    v_exp_f32 v203, v203
    v_mfma_f32_16x16x32_bf16 a[12:15], v[160:163], v[208:211], a[12:15]
    v_exp_f32 v204, v204
    v_mfma_f32_16x16x32_bf16 a[32:35], v[164:167], v[208:211], a[32:35]
    buffer_load_dwordx4 v44, s[8:11], s27 offen offset:2048 nt lds
    v_mfma_f32_16x16x32_bf16 a[52:55], v[168:171], v[208:211], a[52:55]
    v_cvt_pk_bf16_f32 v213, v202, v203
    v_mfma_f32_16x16x32_bf16 a[72:75], v[172:175], v[208:211], a[72:75]
    v_exp_f32 v205, v205
    v_mfma_f32_16x16x32_bf16 a[92:95], v[176:179], v[208:211], a[92:95]
    v_exp_f32 v206, v206
    v_mfma_f32_16x16x32_bf16 a[112:115], v[180:183], v[208:211], a[112:115]
    buffer_load_dwordx4 v45, s[8:11], s27 offen offset:3072 nt lds
    v_mfma_f32_16x16x32_bf16 a[132:135], v[184:187], v[208:211], a[132:135]
    v_cvt_pk_bf16_f32 v214, v204, v205
    v_mfma_f32_16x16x32_bf16 a[152:155], v[188:191], v[208:211], a[152:155]
    v_exp_f32 v207, v207
    v_mfma_f32_16x16x32_bf16 v[248:251], v[60:63], v[208:211], v[248:251]
    s_add_u32 s99, s99, 8192
    s_xor_b32 s26, s99, s3
    s_add_u32 s27, s26, 4096
    s_nop 0
    v_cvt_pk_bf16_f32 v215, v206, v207
    s_sub_u32 s28, s28, 1
    s_cmp_lg_u32 s28, 0
    s_cbranch_scc1 L_loopB
    s_branch L_loop_done
L_loopA:
    s_waitcnt vmcnt(16) lgkmcnt(0)
    s_barrier
    v_mfma_f32_16x16x32_bf16 v[200:203], v[64:67], a[176:179], v[220:223]
    v_exp_f32 v192, v192
    v_mfma_f32_16x16x32_bf16 v[204:207], v[80:83], a[176:179], v[220:223]
    s_add_u32 m0, s72, 0
    v_mfma_f32_16x16x32_bf16 v[200:203], v[68:71], a[180:183], v[200:203]
    v_exp_f32 v193, v193
    v_mfma_f32_16x16x32_bf16 v[204:207], v[84:87], a[180:183], v[204:207]
    ds_read_b128 v[96:99], v46 offset:32768
    v_mfma_f32_16x16x32_bf16 v[200:203], v[72:75], a[184:187], v[200:203]
    v_exp_f32 v194, v194
    v_mfma_f32_16x16x32_bf16 v[204:207], v[88:91], a[184:187], v[204:207]
    buffer_load_dwordx4 v40, s[4:7], s26 offen offset:0 nt lds
    v_mfma_f32_16x16x32_bf16 v[200:203], v[76:79], a[188:191], v[200:203]
    v_cvt_pk_bf16_f32 v208, v192, v193
    v_mfma_f32_16x16x32_bf16 v[204:207], v[92:95], a[188:191], v[204:207]
    v_exp_f32 v195, v195
    v_mfma_f32_16x16x32_bf16 a[16:19], v[160:163], v[212:215], a[16:19]
    buffer_load_dwordx4 v41, s[4:7], s26 offen offset:1024 nt lds
    v_mfma_f32_16x16x32_bf16 a[36:39], v[164:167], v[212:215], a[36:39]
    v_exp_f32 v196, v196
    v_mfma_f32_16x16x32_bf16 a[56:59], v[168:171], v[212:215], a[56:59]
    v_cvt_pk_bf16_f32 v209, v194, v195
    v_mfma_f32_16x16x32_bf16 a[76:79], v[172:175], v[212:215], a[76:79]
    v_exp_f32 v197, v197
    v_mfma_f32_16x16x32_bf16 a[96:99], v[176:179], v[212:215], a[96:99]
    ds_read_b128 v[100:103], v47 offset:32768
    v_exp_f32 v198, v198
    v_mfma_f32_16x16x32_bf16 a[116:119], v[180:183], v[212:215], a[116:119]
    ds_read_b128 v[104:107], v48 offset:32768
    v_mfma_f32_16x16x32_bf16 a[136:139], v[184:187], v[212:215], a[136:139]
    v_cvt_pk_bf16_f32 v210, v196, v197
    v_mfma_f32_16x16x32_bf16 a[156:159], v[188:191], v[212:215], a[156:159]
    v_exp_f32 v199, v199
    v_mfma_f32_16x16x32_bf16 v[252:255], v[60:63], v[212:215], v[252:255]
    ds_read_b128 v[108:111], v49 offset:32768
    s_nop 0
    v_cvt_pk_bf16_f32 v211, v198, v199
    v_mfma_f32_16x16x32_bf16 v[192:195], v[64:67], a[192:195], v[224:227]
    v_exp_f32 v200, v200
    v_mfma_f32_16x16x32_bf16 v[196:199], v[80:83], a[192:195], v[224:227]
    s_add_u32 m0, s72, 4096
    v_mfma_f32_16x16x32_bf16 v[192:195], v[68:71], a[196:199], v[192:195]
    v_exp_f32 v201, v201
    v_mfma_f32_16x16x32_bf16 v[196:199], v[84:87], a[196:199], v[196:199]
    ds_read_b128 v[112:115], v46 offset:36864
    v_mfma_f32_16x16x32_bf16 v[192:195], v[72:75], a[200:203], v[192:195]
    v_exp_f32 v202, v202
    v_mfma_f32_16x16x32_bf16 v[196:199], v[88:91], a[200:203], v[196:199]
    buffer_load_dwordx4 v40, s[4:7], s27 offen offset:0 nt lds
    v_mfma_f32_16x16x32_bf16 v[192:195], v[76:79], a[204:207], v[192:195]
    v_cvt_pk_bf16_f32 v212, v200, v201
    v_mfma_f32_16x16x32_bf16 v[196:199], v[92:95], a[204:207], v[196:199]
    v_exp_f32 v203, v203
    v_mfma_f32_16x16x32_bf16 a[0:3], v[128:131], v[208:211], a[0:3]
    buffer_load_dwordx4 v41, s[4:7], s27 offen offset:1024 nt lds
    v_mfma_f32_16x16x32_bf16 a[20:23], v[132:135], v[208:211], a[20:23]
    v_exp_f32 v204, v204
    v_mfma_f32_16x16x32_bf16 a[40:43], v[136:139], v[208:211], a[40:43]
    v_cvt_pk_bf16_f32 v213, v202, v203
    v_mfma_f32_16x16x32_bf16 a[60:63], v[140:143], v[208:211], a[60:63]
    v_exp_f32 v205, v205
    v_mfma_f32_16x16x32_bf16 a[80:83], v[144:147], v[208:211], a[80:83]
    ds_read_b128 v[116:119], v47 offset:36864
    v_exp_f32 v206, v206
    v_mfma_f32_16x16x32_bf16 a[100:103], v[148:151], v[208:211], a[100:103]
    ds_read_b128 v[120:123], v48 offset:36864
    v_mfma_f32_16x16x32_bf16 a[120:123], v[152:155], v[208:211], a[120:123]
    v_cvt_pk_bf16_f32 v214, v204, v205
    v_mfma_f32_16x16x32_bf16 a[140:143], v[156:159], v[208:211], a[140:143]
    v_exp_f32 v207, v207
    v_mfma_f32_16x16x32_bf16 v[236:239], v[60:63], v[208:211], v[236:239]
    ds_read_b128 v[124:127], v49 offset:36864
    s_nop 0
    v_cvt_pk_bf16_f32 v215, v206, v207
    v_mfma_f32_16x16x32_bf16 v[200:203], v[64:67], a[208:211], v[228:231]
    v_exp_f32 v192, v192
    v_mfma_f32_16x16x32_bf16 v[204:207], v[80:83], a[208:211], v[228:231]
    s_add_u32 m0, s72, 8192
    ds_read_b64_tr_b16 v[160:161], v50 offset:40960
    v_mfma_f32_16x16x32_bf16 v[200:203], v[68:71], a[212:215], v[200:203]
    v_exp_f32 v193, v193
    v_mfma_f32_16x16x32_bf16 v[204:207], v[84:87], a[212:215], v[204:207]
    buffer_load_dwordx4 v44, s[8:11], s26 offen offset:0 nt lds
    v_mfma_f32_16x16x32_bf16 v[200:203], v[72:75], a[216:219], v[200:203]
    v_exp_f32 v194, v194
    v_mfma_f32_16x16x32_bf16 v[204:207], v[88:91], a[216:219], v[204:207]
    v_cvt_pk_bf16_f32 v208, v192, v193
    v_mfma_f32_16x16x32_bf16 v[200:203], v[76:79], a[220:223], v[200:203]
    buffer_load_dwordx4 v45, s[8:11], s26 offen offset:1024 nt lds
    v_mfma_f32_16x16x32_bf16 v[204:207], v[92:95], a[220:223], v[204:207]
    v_exp_f32 v195, v195
    v_mfma_f32_16x16x32_bf16 a[4:7], v[128:131], v[212:215], a[4:7]
    v_exp_f32 v196, v196
    v_mfma_f32_16x16x32_bf16 a[24:27], v[132:135], v[212:215], a[24:27]
    ds_read_b64_tr_b16 v[164:165], v51 offset:40960
    ds_read_b64_tr_b16 v[168:169], v52 offset:40960
    v_mfma_f32_16x16x32_bf16 a[44:47], v[136:139], v[212:215], a[44:47]
    v_cvt_pk_bf16_f32 v209, v194, v195
    v_exp_f32 v197, v197
    v_mfma_f32_16x16x32_bf16 a[64:67], v[140:143], v[212:215], a[64:67]
    ds_read_b64_tr_b16 v[172:173], v53 offset:40960
    v_mfma_f32_16x16x32_bf16 a[84:87], v[144:147], v[212:215], a[84:87]
    ds_read_b64_tr_b16 v[176:177], v54 offset:40960
    v_exp_f32 v198, v198
    v_mfma_f32_16x16x32_bf16 a[104:107], v[148:151], v[212:215], a[104:107]
    ds_read_b64_tr_b16 v[180:181], v55 offset:40960
    v_mfma_f32_16x16x32_bf16 a[124:127], v[152:155], v[212:215], a[124:127]
    v_cvt_pk_bf16_f32 v210, v196, v197
    ds_read_b64_tr_b16 v[184:185], v56 offset:40960
    v_mfma_f32_16x16x32_bf16 a[144:147], v[156:159], v[212:215], a[144:147]
    v_exp_f32 v199, v199
    v_mfma_f32_16x16x32_bf16 v[240:243], v[60:63], v[212:215], v[240:243]
    ds_read_b64_tr_b16 v[188:189], v57 offset:40960
    s_nop 0
    v_cvt_pk_bf16_f32 v211, v198, v199
    v_mfma_f32_16x16x32_bf16 v[192:195], v[64:67], a[224:227], v[232:235]
    v_exp_f32 v200, v200
    v_mfma_f32_16x16x32_bf16 v[196:199], v[80:83], a[224:227], v[232:235]
    s_add_u32 m0, s72, 12288
    ds_read_b64_tr_b16 v[162:163], v50 offset:45056
    v_mfma_f32_16x16x32_bf16 v[192:195], v[68:71], a[228:231], v[192:195]
    v_exp_f32 v201, v201
    v_mfma_f32_16x16x32_bf16 v[196:199], v[84:87], a[228:231], v[196:199]
    buffer_load_dwordx4 v44, s[8:11], s27 offen offset:0 nt lds
    v_mfma_f32_16x16x32_bf16 v[192:195], v[72:75], a[232:235], v[192:195]
    v_exp_f32 v202, v202
    v_mfma_f32_16x16x32_bf16 v[196:199], v[88:91], a[232:235], v[196:199]
    v_cvt_pk_bf16_f32 v212, v200, v201
    v_mfma_f32_16x16x32_bf16 v[192:195], v[76:79], a[236:239], v[192:195]
    buffer_load_dwordx4 v45, s[8:11], s27 offen offset:1024 nt lds
    v_mfma_f32_16x16x32_bf16 v[196:199], v[92:95], a[236:239], v[196:199]
    v_exp_f32 v203, v203
    v_mfma_f32_16x16x32_bf16 a[8:11], v[128:131], v[208:211], a[8:11]
    v_exp_f32 v204, v204
    v_mfma_f32_16x16x32_bf16 a[28:31], v[132:135], v[208:211], a[28:31]
    ds_read_b64_tr_b16 v[166:167], v51 offset:45056
    ds_read_b64_tr_b16 v[170:171], v52 offset:45056
    v_mfma_f32_16x16x32_bf16 a[48:51], v[136:139], v[208:211], a[48:51]
    v_cvt_pk_bf16_f32 v213, v202, v203
    v_exp_f32 v205, v205
    v_mfma_f32_16x16x32_bf16 a[68:71], v[140:143], v[208:211], a[68:71]
    ds_read_b64_tr_b16 v[174:175], v53 offset:45056
    v_mfma_f32_16x16x32_bf16 a[88:91], v[144:147], v[208:211], a[88:91]
    ds_read_b64_tr_b16 v[178:179], v54 offset:45056
    v_exp_f32 v206, v206
    v_mfma_f32_16x16x32_bf16 a[108:111], v[148:151], v[208:211], a[108:111]
    ds_read_b64_tr_b16 v[182:183], v55 offset:45056
    v_mfma_f32_16x16x32_bf16 a[128:131], v[152:155], v[208:211], a[128:131]
    v_cvt_pk_bf16_f32 v214, v204, v205
    ds_read_b64_tr_b16 v[186:187], v56 offset:45056
    v_mfma_f32_16x16x32_bf16 a[148:151], v[156:159], v[208:211], a[148:151]
    v_exp_f32 v207, v207
    v_mfma_f32_16x16x32_bf16 v[244:247], v[60:63], v[208:211], v[244:247]
    ds_read_b64_tr_b16 v[190:191], v57 offset:45056
    s_nop 0
    v_cvt_pk_bf16_f32 v215, v206, v207
    s_waitcnt lgkmcnt(0)
    v_mfma_f32_16x16x32_bf16 v[200:203], v[96:99], a[160:163], v[216:219]
    v_exp_f32 v192, v192
    v_mfma_f32_16x16x32_bf16 v[204:207], v[112:115], a[160:163], v[216:219]
    v_mfma_f32_16x16x32_bf16 v[200:203], v[100:103], a[164:167], v[200:203]
    s_add_u32 s99, s99, 8192
    s_xor_b32 s26, s99, s3
    s_add_u32 s27, s26, 4096
    v_mfma_f32_16x16x32_bf16 v[204:207], v[116:119], a[164:167], v[204:207]
    v_exp_f32 v193, v193
    v_mfma_f32_16x16x32_bf16 v[200:203], v[104:107], a[168:171], v[200:203]
    v_exp_f32 v194, v194
    v_mfma_f32_16x16x32_bf16 v[204:207], v[120:123], a[168:171], v[204:207]
    v_mfma_f32_16x16x32_bf16 v[200:203], v[108:111], a[172:175], v[200:203]
    v_cvt_pk_bf16_f32 v208, v192, v193
    v_mfma_f32_16x16x32_bf16 v[204:207], v[124:127], a[172:175], v[204:207]
    v_exp_f32 v195, v195
    v_mfma_f32_16x16x32_bf16 a[12:15], v[128:131], v[212:215], a[12:15]
    v_exp_f32 v196, v196
    v_mfma_f32_16x16x32_bf16 a[32:35], v[132:135], v[212:215], a[32:35]
    v_mfma_f32_16x16x32_bf16 a[52:55], v[136:139], v[212:215], a[52:55]
    v_cvt_pk_bf16_f32 v209, v194, v195
    v_mfma_f32_16x16x32_bf16 a[72:75], v[140:143], v[212:215], a[72:75]
    v_exp_f32 v197, v197
    v_mfma_f32_16x16x32_bf16 a[92:95], v[144:147], v[212:215], a[92:95]
    v_exp_f32 v198, v198
    v_mfma_f32_16x16x32_bf16 a[112:115], v[148:151], v[212:215], a[112:115]
    v_mfma_f32_16x16x32_bf16 a[132:135], v[152:155], v[212:215], a[132:135]
    v_cvt_pk_bf16_f32 v210, v196, v197
    v_mfma_f32_16x16x32_bf16 a[152:155], v[156:159], v[212:215], a[152:155]
    v_exp_f32 v199, v199
    v_mfma_f32_16x16x32_bf16 v[248:251], v[60:63], v[212:215], v[248:251]
    s_nop 0
    v_cvt_pk_bf16_f32 v211, v198, v199
    s_waitcnt vmcnt(16) lgkmcnt(0)
    s_barrier
    v_xor_b32 v46, 16384, v46
    v_xor_b32 v47, 16384, v47
    v_xor_b32 v48, 16384, v48
    v_xor_b32 v49, 16384, v49
    v_xor_b32 v50, 16384, v50
    v_xor_b32 v51, 16384, v51
    v_xor_b32 v52, 16384, v52
    v_xor_b32 v53, 16384, v53
    v_xor_b32 v54, 16384, v54
    v_xor_b32 v55, 16384, v55
    v_xor_b32 v56, 16384, v56
    v_xor_b32 v57, 16384, v57
    v_mfma_f32_16x16x32_bf16 v[192:195], v[96:99], a[176:179], v[220:223]
    v_exp_f32 v200, v200
    v_mfma_f32_16x16x32_bf16 v[196:199], v[112:115], a[176:179], v[220:223]
    s_add_u32 m0, s72, 32768
    v_mfma_f32_16x16x32_bf16 v[192:195], v[100:103], a[180:183], v[192:195]
    v_exp_f32 v201, v201
    v_mfma_f32_16x16x32_bf16 v[196:199], v[116:119], a[180:183], v[196:199]
    ds_read_b128 v[64:67], v46 offset:0
    v_mfma_f32_16x16x32_bf16 v[192:195], v[104:107], a[184:187], v[192:195]
    v_exp_f32 v202, v202
    v_mfma_f32_16x16x32_bf16 v[196:199], v[120:123], a[184:187], v[196:199]
    buffer_load_dwordx4 v40, s[4:7], s26 offen offset:0 nt lds
    v_mfma_f32_16x16x32_bf16 v[192:195], v[108:111], a[188:191], v[192:195]
    v_cvt_pk_bf16_f32 v212, v200, v201
    v_mfma_f32_16x16x32_bf16 v[196:199], v[124:127], a[188:191], v[196:199]
    v_exp_f32 v203, v203
    v_mfma_f32_16x16x32_bf16 a[16:19], v[128:131], v[208:211], a[16:19]
    buffer_load_dwordx4 v41, s[4:7], s26 offen offset:1024 nt lds
    v_mfma_f32_16x16x32_bf16 a[36:39], v[132:135], v[208:211], a[36:39]
    v_exp_f32 v204, v204
    v_mfma_f32_16x16x32_bf16 a[56:59], v[136:139], v[208:211], a[56:59]
    v_cvt_pk_bf16_f32 v213, v202, v203
    v_mfma_f32_16x16x32_bf16 a[76:79], v[140:143], v[208:211], a[76:79]
    v_exp_f32 v205, v205
    v_mfma_f32_16x16x32_bf16 a[96:99], v[144:147], v[208:211], a[96:99]
    ds_read_b128 v[68:71], v47 offset:0
    v_exp_f32 v206, v206
    v_mfma_f32_16x16x32_bf16 a[116:119], v[148:151], v[208:211], a[116:119]
    ds_read_b128 v[72:75], v48 offset:0
    v_mfma_f32_16x16x32_bf16 a[136:139], v[152:155], v[208:211], a[136:139]
    v_cvt_pk_bf16_f32 v214, v204, v205
    v_mfma_f32_16x16x32_bf16 a[156:159], v[156:159], v[208:211], a[156:159]
    v_exp_f32 v207, v207
    v_mfma_f32_16x16x32_bf16 v[252:255], v[60:63], v[208:211], v[252:255]
    ds_read_b128 v[76:79], v49 offset:0
    s_nop 0
    v_cvt_pk_bf16_f32 v215, v206, v207
    v_mfma_f32_16x16x32_bf16 v[200:203], v[96:99], a[192:195], v[224:227]
    v_exp_f32 v192, v192
    v_mfma_f32_16x16x32_bf16 v[204:207], v[112:115], a[192:195], v[224:227]
    s_add_u32 m0, s72, 36864
    v_mfma_f32_16x16x32_bf16 v[200:203], v[100:103], a[196:199], v[200:203]
    v_exp_f32 v193, v193
    v_mfma_f32_16x16x32_bf16 v[204:207], v[116:119], a[196:199], v[204:207]
    ds_read_b128 v[80:83], v46 offset:4096
    v_mfma_f32_16x16x32_bf16 v[200:203], v[104:107], a[200:203], v[200:203]
    v_exp_f32 v194, v194
    v_mfma_f32_16x16x32_bf16 v[204:207], v[120:123], a[200:203], v[204:207]
    buffer_load_dwordx4 v40, s[4:7], s27 offen offset:0 nt lds
    v_mfma_f32_16x16x32_bf16 v[200:203], v[108:111], a[204:207], v[200:203]
    v_cvt_pk_bf16_f32 v208, v192, v193
    v_mfma_f32_16x16x32_bf16 v[204:207], v[124:127], a[204:207], v[204:207]
    v_exp_f32 v195, v195
    v_mfma_f32_16x16x32_bf16 a[0:3], v[160:163], v[212:215], a[0:3]
    buffer_load_dwordx4 v41, s[4:7], s27 offen offset:1024 nt lds
    v_mfma_f32_16x16x32_bf16 a[20:23], v[164:167], v[212:215], a[20:23]
    v_exp_f32 v196, v196
    v_mfma_f32_16x16x32_bf16 a[40:43], v[168:171], v[212:215], a[40:43]
    v_cvt_pk_bf16_f32 v209, v194, v195
    v_mfma_f32_16x16x32_bf16 a[60:63], v[172:175], v[212:215], a[60:63]
    v_exp_f32 v197, v197
    v_mfma_f32_16x16x32_bf16 a[80:83], v[176:179], v[212:215], a[80:83]
    ds_read_b128 v[84:87], v47 offset:4096
    v_exp_f32 v198, v198
    v_mfma_f32_16x16x32_bf16 a[100:103], v[180:183], v[212:215], a[100:103]
    ds_read_b128 v[88:91], v48 offset:4096
    v_mfma_f32_16x16x32_bf16 a[120:123], v[184:187], v[212:215], a[120:123]
    v_cvt_pk_bf16_f32 v210, v196, v197
    v_mfma_f32_16x16x32_bf16 a[140:143], v[188:191], v[212:215], a[140:143]
    v_exp_f32 v199, v199
    v_mfma_f32_16x16x32_bf16 v[236:239], v[60:63], v[212:215], v[236:239]
    ds_read_b128 v[92:95], v49 offset:4096
    s_nop 0
    v_cvt_pk_bf16_f32 v211, v198, v199
    v_mfma_f32_16x16x32_bf16 v[192:195], v[96:99], a[208:211], v[228:231]
    v_exp_f32 v200, v200
    v_mfma_f32_16x16x32_bf16 v[196:199], v[112:115], a[208:211], v[228:231]
    s_add_u32 m0, s72, 40960
    ds_read_b64_tr_b16 v[128:129], v50 offset:8192
    v_mfma_f32_16x16x32_bf16 v[192:195], v[100:103], a[212:215], v[192:195]
    v_exp_f32 v201, v201
    v_mfma_f32_16x16x32_bf16 v[196:199], v[116:119], a[212:215], v[196:199]
    buffer_load_dwordx4 v44, s[8:11], s26 offen offset:0 nt lds
    v_mfma_f32_16x16x32_bf16 v[192:195], v[104:107], a[216:219], v[192:195]
    v_exp_f32 v202, v202
    v_mfma_f32_16x16x32_bf16 v[196:199], v[120:123], a[216:219], v[196:199]
    v_cvt_pk_bf16_f32 v212, v200, v201
    v_mfma_f32_16x16x32_bf16 v[192:195], v[108:111], a[220:223], v[192:195]
    buffer_load_dwordx4 v45, s[8:11], s26 offen offset:1024 nt lds
    v_mfma_f32_16x16x32_bf16 v[196:199], v[124:127], a[220:223], v[196:199]
    v_exp_f32 v203, v203
    v_mfma_f32_16x16x32_bf16 a[4:7], v[160:163], v[208:211], a[4:7]
    v_exp_f32 v204, v204
    v_mfma_f32_16x16x32_bf16 a[24:27], v[164:167], v[208:211], a[24:27]
    ds_read_b64_tr_b16 v[132:133], v51 offset:8192
    ds_read_b64_tr_b16 v[136:137], v52 offset:8192
    v_mfma_f32_16x16x32_bf16 a[44:47], v[168:171], v[208:211], a[44:47]
    v_cvt_pk_bf16_f32 v213, v202, v203
    v_exp_f32 v205, v205
    v_mfma_f32_16x16x32_bf16 a[64:67], v[172:175], v[208:211], a[64:67]
    ds_read_b64_tr_b16 v[140:141], v53 offset:8192
    v_mfma_f32_16x16x32_bf16 a[84:87], v[176:179], v[208:211], a[84:87]
    ds_read_b64_tr_b16 v[144:145], v54 offset:8192
    v_exp_f32 v206, v206
    v_mfma_f32_16x16x32_bf16 a[104:107], v[180:183], v[208:211], a[104:107]
    ds_read_b64_tr_b16 v[148:149], v55 offset:8192
    v_mfma_f32_16x16x32_bf16 a[124:127], v[184:187], v[208:211], a[124:127]
    v_cvt_pk_bf16_f32 v214, v204, v205
    ds_read_b64_tr_b16 v[152:153], v56 offset:8192
    v_mfma_f32_16x16x32_bf16 a[144:147], v[188:191], v[208:211], a[144:147]
    v_exp_f32 v207, v207
    v_mfma_f32_16x16x32_bf16 v[240:243], v[60:63], v[208:211], v[240:243]
    ds_read_b64_tr_b16 v[156:157], v57 offset:8192
    s_nop 0
    v_cvt_pk_bf16_f32 v215, v206, v207
    v_mfma_f32_16x16x32_bf16 v[200:203], v[96:99], a[224:227], v[232:235]
    v_exp_f32 v192, v192
    v_mfma_f32_16x16x32_bf16 v[204:207], v[112:115], a[224:227], v[232:235]
    s_add_u32 m0, s72, 45056
    ds_read_b64_tr_b16 v[130:131], v50 offset:12288
    v_mfma_f32_16x16x32_bf16 v[200:203], v[100:103], a[228:231], v[200:203]
    v_exp_f32 v193, v193
    v_mfma_f32_16x16x32_bf16 v[204:207], v[116:119], a[228:231], v[204:207]
    buffer_load_dwordx4 v44, s[8:11], s27 offen offset:0 nt lds
    v_mfma_f32_16x16x32_bf16 v[200:203], v[104:107], a[232:235], v[200:203]
    v_exp_f32 v194, v194
    v_mfma_f32_16x16x32_bf16 v[204:207], v[120:123], a[232:235], v[204:207]
    v_cvt_pk_bf16_f32 v208, v192, v193
    v_mfma_f32_16x16x32_bf16 v[200:203], v[108:111], a[236:239], v[200:203]
    buffer_load_dwordx4 v45, s[8:11], s27 offen offset:1024 nt lds
    v_mfma_f32_16x16x32_bf16 v[204:207], v[124:127], a[236:239], v[204:207]
    v_exp_f32 v195, v195
    v_mfma_f32_16x16x32_bf16 a[8:11], v[160:163], v[212:215], a[8:11]
    v_exp_f32 v196, v196
    v_mfma_f32_16x16x32_bf16 a[28:31], v[164:167], v[212:215], a[28:31]
    ds_read_b64_tr_b16 v[134:135], v51 offset:12288
    ds_read_b64_tr_b16 v[138:139], v52 offset:12288
    v_mfma_f32_16x16x32_bf16 a[48:51], v[168:171], v[212:215], a[48:51]
    v_cvt_pk_bf16_f32 v209, v194, v195
    v_exp_f32 v197, v197
    v_mfma_f32_16x16x32_bf16 a[68:71], v[172:175], v[212:215], a[68:71]
    ds_read_b64_tr_b16 v[142:143], v53 offset:12288
    v_mfma_f32_16x16x32_bf16 a[88:91], v[176:179], v[212:215], a[88:91]
    ds_read_b64_tr_b16 v[146:147], v54 offset:12288
    v_exp_f32 v198, v198
    v_mfma_f32_16x16x32_bf16 a[108:111], v[180:183], v[212:215], a[108:111]
    ds_read_b64_tr_b16 v[150:151], v55 offset:12288
    v_mfma_f32_16x16x32_bf16 a[128:131], v[184:187], v[212:215], a[128:131]
    v_cvt_pk_bf16_f32 v210, v196, v197
    ds_read_b64_tr_b16 v[154:155], v56 offset:12288
    v_mfma_f32_16x16x32_bf16 a[148:151], v[188:191], v[212:215], a[148:151]
    v_exp_f32 v199, v199
    v_mfma_f32_16x16x32_bf16 v[244:247], v[60:63], v[212:215], v[244:247]
    ds_read_b64_tr_b16 v[158:159], v57 offset:12288
    s_nop 0
    v_cvt_pk_bf16_f32 v211, v198, v199
    s_waitcnt lgkmcnt(0)
    v_mfma_f32_16x16x32_bf16 v[192:195], v[64:67], a[160:163], v[216:219]
    v_exp_f32 v200, v200
    v_mfma_f32_16x16x32_bf16 v[196:199], v[80:83], a[160:163], v[216:219]
    v_mfma_f32_16x16x32_bf16 v[192:195], v[68:71], a[164:167], v[192:195]
    s_add_u32 s99, s99, 8192
    s_xor_b32 s26, s99, s3
    s_add_u32 s27, s26, 4096
    s_xor_b32 s72, s72, 16384
    v_mfma_f32_16x16x32_bf16 v[196:199], v[84:87], a[164:167], v[196:199]
    v_exp_f32 v201, v201
    v_mfma_f32_16x16x32_bf16 v[192:195], v[72:75], a[168:171], v[192:195]
    v_exp_f32 v202, v202
    v_mfma_f32_16x16x32_bf16 v[196:199], v[88:91], a[168:171], v[196:199]
    v_mfma_f32_16x16x32_bf16 v[192:195], v[76:79], a[172:175], v[192:195]
    v_cvt_pk_bf16_f32 v212, v200, v201
    v_mfma_f32_16x16x32_bf16 v[196:199], v[92:95], a[172:175], v[196:199]
    v_exp_f32 v203, v203
    v_mfma_f32_16x16x32_bf16 a[12:15], v[160:163], v[208:211], a[12:15]
    v_exp_f32 v204, v204
    v_mfma_f32_16x16x32_bf16 a[32:35], v[164:167], v[208:211], a[32:35]
    v_mfma_f32_16x16x32_bf16 a[52:55], v[168:171], v[208:211], a[52:55]
    v_cvt_pk_bf16_f32 v213, v202, v203
    v_mfma_f32_16x16x32_bf16 a[72:75], v[172:175], v[208:211], a[72:75]
    v_exp_f32 v205, v205
    v_mfma_f32_16x16x32_bf16 a[92:95], v[176:179], v[208:211], a[92:95]
    v_exp_f32 v206, v206
    v_mfma_f32_16x16x32_bf16 a[112:115], v[180:183], v[208:211], a[112:115]
    v_mfma_f32_16x16x32_bf16 a[132:135], v[184:187], v[208:211], a[132:135]
    v_cvt_pk_bf16_f32 v214, v204, v205
    v_mfma_f32_16x16x32_bf16 a[152:155], v[188:191], v[208:211], a[152:155]
    v_exp_f32 v207, v207
    v_mfma_f32_16x16x32_bf16 v[248:251], v[60:63], v[208:211], v[248:251]
    s_nop 0
    v_cvt_pk_bf16_f32 v215, v206, v207
    s_sub_u32 s28, s28, 1
    s_cmp_lg_u32 s28, 0
    s_cbranch_scc1 L_loopA
L_loop_done:
    s_nop 1
    v_mfma_f32_16x16x32_bf16 a[16:19], v[160:163], v[212:215], a[16:19]
    v_mfma_f32_16x16x32_bf16 a[36:39], v[164:167], v[212:215], a[36:39]
    v_mfma_f32_16x16x32_bf16 a[56:59], v[168:171], v[212:215], a[56:59]
    v_mfma_f32_16x16x32_bf16 a[76:79], v[172:175], v[212:215], a[76:79]
    v_mfma_f32_16x16x32_bf16 a[96:99], v[176:179], v[212:215], a[96:99]
    v_mfma_f32_16x16x32_bf16 a[116:119], v[180:183], v[212:215], a[116:119]
    v_mfma_f32_16x16x32_bf16 a[136:139], v[184:187], v[212:215], a[136:139]
    v_mfma_f32_16x16x32_bf16 a[156:159], v[188:191], v[212:215], a[156:159]
    v_mfma_f32_16x16x32_bf16 v[252:255], v[60:63], v[212:215], v[252:255]
    s_waitcnt vmcnt(0) lgkmcnt(0)
    s_lshl_b32 s29, s62, 17
    s_lshl_b32 s30, s24, 8
    s_add_u32 s29, s29, s30
    s_cmp_eq_u32 s64, 1
    s_cselect_b64 s[30:31], s[54:55], s[44:45]
    s_add_u32 s84, s30, s29
    s_addc_u32 s85, s31, 0
    s_and_b32 s85, s85, 0xffff
    s_sub_u32 s86, 0x400000, s29
    s_mov_b32 s87, 0x20000
    s_mov_b32 s73, s63
    s_lshl_b32 s74, s24, 13
    s_add_u32 s74, s74, 131072
    s_xor_b32 s67, s68, 32768
    s_add_u32 s67, s67, 10240
    v_lshrrev_b32 v1, 4, v0
    v_and_b32 v2, 15, v0
    v_and_b32 v3, 1, v1
    v_lshlrev_b32 v3, 1, v3
    v_xor_b32 v4, v3, v0
    v_and_b32 v4, 3, v4
    v_lshlrev_b32 v4, 4, v4
    v_lshrrev_b32 v5, 2, v0
    v_lshl_add_u32 v16, v5, 10, v4
    v_add_u32 v17, 15360, v16
    v_add_u32 v18, 30720, v16
    v_add_u32 v19, 46080, v16
    s_add_u32 m0, s74, 0
    s_xor_b32 s29, s73, 0
    s_and_b32 s30, s29, 1
    s_lshl_b32 s30, s30, 17
    s_lshr_b32 s29, s29, 1
    s_lshl_b32 s29, s29, 6
    s_add_u32 s29, s29, s30
    buffer_load_dwordx4 v16, s[84:87], s29 offen offset:0 lds
    buffer_load_dwordx4 v17, s[84:87], s29 offen offset:1024 lds
    buffer_load_dwordx4 v18, s[84:87], s29 offen offset:2048 lds
    buffer_load_dwordx4 v19, s[84:87], s29 offen offset:3072 lds
    s_add_u32 m0, s74, 4096
    s_add_u32 s29, s29, 65536
    buffer_load_dwordx4 v16, s[84:87], s29 offen offset:0 lds
    buffer_load_dwordx4 v17, s[84:87], s29 offen offset:1024 lds
    buffer_load_dwordx4 v18, s[84:87], s29 offen offset:2048 lds
    buffer_load_dwordx4 v19, s[84:87], s29 offen offset:3072 lds
    v_lshrrev_b32 v5, 2, v2
    v_lshl_add_u32 v5, v1, 2, v5
    v_bfe_u32 v6, v2, 1, 1
    v_xor_b32 v6, v6, v3
    v_lshlrev_b32 v6, 4, v6
    v_lshl_add_u32 v6, v5, 6, v6
    v_and_b32 v7, 1, v2
    v_lshl_add_u32 v6, v7, 3, v6
    v_add_u32 v20, s74, v6
    v_xor_b32 v21, 32, v20
    v_add_u32 v22, s67, v6
    v_xor_b32 v23, 32, v22
    s_cmp_eq_u32 s64, 1
    s_cbranch_scc1 L_nobar
    s_barrier
L_nobar:
    v_mov_b32 v2, 0x5d800000
    s_mov_b64 s[30:31], 0
    v_cmp_nlt_f32 vcc, v236, v2
    s_nop 1
    s_or_b64 s[30:31], s[30:31], vcc
    v_cmp_nlt_f32 vcc, v240, v2
    s_nop 1
    s_or_b64 s[30:31], s[30:31], vcc
    v_cmp_nlt_f32 vcc, v244, v2
    s_nop 1
    s_or_b64 s[30:31], s[30:31], vcc
    v_cmp_nlt_f32 vcc, v248, v2
    s_nop 1
    s_or_b64 s[30:31], s[30:31], vcc
    v_cmp_nlt_f32 vcc, v252, v2
    s_nop 1
    s_or_b64 s[30:31], s[30:31], vcc
    s_cmp_eq_u64 s[30:31], 0
    s_cbranch_scc1 L_ok
    v_lshrrev_b32 v1, 4, v0
    v_and_b32 v2, 15, v0
    v_xor_b32 v5, v2, v1
    v_lshlrev_b32 v6, 8, v1
    v_xor_b32 v7, 0, v5
    v_lshl_add_u32 v40, v7, 4, v6
    v_xor_b32 v7, 4, v5
    v_lshl_add_u32 v41, v7, 4, v6
    v_xor_b32 v7, 8, v5
    v_lshl_add_u32 v42, v7, 4, v6
    v_xor_b32 v7, 12, v5
    v_lshl_add_u32 v43, v7, 4, v6
    v_lshlrev_b32 v7, 1, v1
    v_xor_b32 v5, v2, v7
    v_xor_b32 v7, 0, v5
    v_lshl_add_u32 v44, v7, 4, v6
    v_xor_b32 v7, 8, v5
    v_lshl_add_u32 v45, v7, 4, v6
    v_xor_b32 v5, v1, v2
    v_lshlrev_b32 v5, 4, v5
    v_lshl_add_u32 v5, v2, 8, v5
    s_lshl_b32 s29, s35, 7
    s_cmp_eq_u32 s64, 1
    s_cselect_b32 s30, 0, s29
    v_xor_b32 v5, s30, v5
    v_add_u32 v5, s68, v5
    v_xor_b32 v46, 0, v5
    v_xor_b32 v47, 64, v5
    v_xor_b32 v48, 128, v5
    v_xor_b32 v49, 192, v5
    v_lshrrev_b32 v5, 2, v2
    v_lshl_add_u32 v5, v1, 2, v5
    v_and_b32 v6, 7, v5
    v_lshlrev_b32 v6, 1, v6
    v_bfe_u32 v7, v2, 1, 1
    v_xor_b32 v6, v6, v7
    v_lshlrev_b32 v6, 4, v6
    v_lshl_add_u32 v6, v5, 8, v6
    v_and_b32 v7, 1, v2
    v_lshl_add_u32 v6, v7, 3, v6
    v_xor_b32 v6, s29, v6
    v_add_u32 v6, s68, v6
    v_xor_b32 v50, 0, v6
    v_xor_b32 v51, 32, v6
    v_xor_b32 v52, 64, v6
    v_xor_b32 v53, 96, v6
    v_xor_b32 v54, 128, v6
    v_xor_b32 v55, 160, v6
    v_xor_b32 v56, 192, v6
    v_xor_b32 v57, 224, v6
    v_mov_b32 v216, 0xff800000
    v_mov_b32 v220, 0xff800000
    v_mov_b32 v224, 0xff800000
    v_mov_b32 v228, 0xff800000
    v_mov_b32 v232, 0xff800000
    s_mov_b32 s26, 0
L_slow1:
    s_add_u32 s27, s26, 4096
    s_add_u32 m0, s68, 0
    s_nop 0
    buffer_load_dwordx4 v40, s[4:7], s26 offen offset:0 nt lds
    buffer_load_dwordx4 v41, s[4:7], s26 offen offset:1024 nt lds
    buffer_load_dwordx4 v42, s[4:7], s26 offen offset:2048 nt lds
    buffer_load_dwordx4 v43, s[4:7], s26 offen offset:3072 nt lds
    s_add_u32 m0, s68, 4096
    s_nop 0
    buffer_load_dwordx4 v40, s[4:7], s27 offen offset:0 nt lds
    buffer_load_dwordx4 v41, s[4:7], s27 offen offset:1024 nt lds
    buffer_load_dwordx4 v42, s[4:7], s27 offen offset:2048 nt lds
    buffer_load_dwordx4 v43, s[4:7], s27 offen offset:3072 nt lds
    s_waitcnt vmcnt(0)
    ds_read_b128 v[64:67], v46 offset:0
    ds_read_b128 v[68:71], v47 offset:0
    ds_read_b128 v[72:75], v48 offset:0
    ds_read_b128 v[76:79], v49 offset:0
    ds_read_b128 v[80:83], v46 offset:4096
    ds_read_b128 v[84:87], v47 offset:4096
    ds_read_b128 v[88:91], v48 offset:4096
    ds_read_b128 v[92:95], v49 offset:4096
    s_waitcnt lgkmcnt(0)
    v_mfma_f32_16x16x32_bf16 v[192:195], v[64:67], a[160:163], 0
    v_mfma_f32_16x16x32_bf16 v[196:199], v[80:83], a[160:163], 0
    v_mfma_f32_16x16x32_bf16 v[192:195], v[68:71], a[164:167], v[192:195]
    v_mfma_f32_16x16x32_bf16 v[196:199], v[84:87], a[164:167], v[196:199]
    v_mfma_f32_16x16x32_bf16 v[192:195], v[72:75], a[168:171], v[192:195]
    v_mfma_f32_16x16x32_bf16 v[196:199], v[88:91], a[168:171], v[196:199]
    v_mfma_f32_16x16x32_bf16 v[192:195], v[76:79], a[172:175], v[192:195]
    v_mfma_f32_16x16x32_bf16 v[196:199], v[92:95], a[172:175], v[196:199]
    s_nop 7
    v_max3_f32 v216, v216, v192, v193
    v_max3_f32 v216, v216, v194, v195
    v_max3_f32 v216, v216, v196, v197
    v_max3_f32 v216, v216, v198, v199
    v_mfma_f32_16x16x32_bf16 v[192:195], v[64:67], a[176:179], 0
    v_mfma_f32_16x16x32_bf16 v[196:199], v[80:83], a[176:179], 0
    v_mfma_f32_16x16x32_bf16 v[192:195], v[68:71], a[180:183], v[192:195]
    v_mfma_f32_16x16x32_bf16 v[196:199], v[84:87], a[180:183], v[196:199]
    v_mfma_f32_16x16x32_bf16 v[192:195], v[72:75], a[184:187], v[192:195]
    v_mfma_f32_16x16x32_bf16 v[196:199], v[88:91], a[184:187], v[196:199]
    v_mfma_f32_16x16x32_bf16 v[192:195], v[76:79], a[188:191], v[192:195]
    v_mfma_f32_16x16x32_bf16 v[196:199], v[92:95], a[188:191], v[196:199]
    s_nop 7
    v_max3_f32 v220, v220, v192, v193
    v_max3_f32 v220, v220, v194, v195
    v_max3_f32 v220, v220, v196, v197
    v_max3_f32 v220, v220, v198, v199
    v_mfma_f32_16x16x32_bf16 v[192:195], v[64:67], a[192:195], 0
    v_mfma_f32_16x16x32_bf16 v[196:199], v[80:83], a[192:195], 0
    v_mfma_f32_16x16x32_bf16 v[192:195], v[68:71], a[196:199], v[192:195]
    v_mfma_f32_16x16x32_bf16 v[196:199], v[84:87], a[196:199], v[196:199]
    v_mfma_f32_16x16x32_bf16 v[192:195], v[72:75], a[200:203], v[192:195]
    v_mfma_f32_16x16x32_bf16 v[196:199], v[88:91], a[200:203], v[196:199]
    v_mfma_f32_16x16x32_bf16 v[192:195], v[76:79], a[204:207], v[192:195]
    v_mfma_f32_16x16x32_bf16 v[196:199], v[92:95], a[204:207], v[196:199]
    s_nop 7
    v_max3_f32 v224, v224, v192, v193
    v_max3_f32 v224, v224, v194, v195
    v_max3_f32 v224, v224, v196, v197
    v_max3_f32 v224, v224, v198, v199
    v_mfma_f32_16x16x32_bf16 v[192:195], v[64:67], a[208:211], 0
    v_mfma_f32_16x16x32_bf16 v[196:199], v[80:83], a[208:211], 0
    v_mfma_f32_16x16x32_bf16 v[192:195], v[68:71], a[212:215], v[192:195]
    v_mfma_f32_16x16x32_bf16 v[196:199], v[84:87], a[212:215], v[196:199]
    v_mfma_f32_16x16x32_bf16 v[192:195], v[72:75], a[216:219], v[192:195]
    v_mfma_f32_16x16x32_bf16 v[196:199], v[88:91], a[216:219], v[196:199]
    v_mfma_f32_16x16x32_bf16 v[192:195], v[76:79], a[220:223], v[192:195]
    v_mfma_f32_16x16x32_bf16 v[196:199], v[92:95], a[220:223], v[196:199]
    s_nop 7
    v_max3_f32 v228, v228, v192, v193
    v_max3_f32 v228, v228, v194, v195
    v_max3_f32 v228, v228, v196, v197
    v_max3_f32 v228, v228, v198, v199
    v_mfma_f32_16x16x32_bf16 v[192:195], v[64:67], a[224:227], 0
    v_mfma_f32_16x16x32_bf16 v[196:199], v[80:83], a[224:227], 0
    v_mfma_f32_16x16x32_bf16 v[192:195], v[68:71], a[228:231], v[192:195]
    v_mfma_f32_16x16x32_bf16 v[196:199], v[84:87], a[228:231], v[196:199]
    v_mfma_f32_16x16x32_bf16 v[192:195], v[72:75], a[232:235], v[192:195]
    v_mfma_f32_16x16x32_bf16 v[196:199], v[88:91], a[232:235], v[196:199]
    v_mfma_f32_16x16x32_bf16 v[192:195], v[76:79], a[236:239], v[192:195]
    v_mfma_f32_16x16x32_bf16 v[196:199], v[92:95], a[236:239], v[196:199]
    s_nop 7
    v_max3_f32 v232, v232, v192, v193
    v_max3_f32 v232, v232, v194, v195
    v_max3_f32 v232, v232, v196, v197
    v_max3_f32 v232, v232, v198, v199
    s_add_u32 s26, s26, 8192
    s_cmp_lt_u32 s26, 131072
    s_cbranch_scc1 L_slow1
    v_mov_b32 v217, v216
    v_mov_b32 v221, v220
    v_mov_b32 v225, v224
    v_mov_b32 v229, v228
    v_mov_b32 v233, v232
    s_nop 1
    v_permlane32_swap_b32 v216, v217
    v_permlane32_swap_b32 v220, v221
    v_permlane32_swap_b32 v224, v225
    v_permlane32_swap_b32 v228, v229
    v_permlane32_swap_b32 v232, v233
    s_nop 1
    v_max_f32 v216, v216, v217
    v_mov_b32 v217, v216
    v_max_f32 v220, v220, v221
    v_mov_b32 v221, v220
    v_max_f32 v224, v224, v225
    v_mov_b32 v225, v224
    v_max_f32 v228, v228, v229
    v_mov_b32 v229, v228
    v_max_f32 v232, v232, v233
    v_mov_b32 v233, v232
    s_nop 1
    v_permlane16_swap_b32 v216, v217
    v_permlane16_swap_b32 v220, v221
    v_permlane16_swap_b32 v224, v225
    v_permlane16_swap_b32 v228, v229
    v_permlane16_swap_b32 v232, v233
    s_nop 1
    v_max_f32 v216, v216, v217
    v_sub_f32 v216, 0, v216
    v_mov_b32 v217, v216
    v_mov_b32 v218, v216
    v_mov_b32 v219, v216
    v_max_f32 v220, v220, v221
    v_sub_f32 v220, 0, v220
    v_mov_b32 v221, v220
    v_mov_b32 v222, v220
    v_mov_b32 v223, v220
    v_max_f32 v224, v224, v225
    v_sub_f32 v224, 0, v224
    v_mov_b32 v225, v224
    v_mov_b32 v226, v224
    v_mov_b32 v227, v224
    v_max_f32 v228, v228, v229
    v_sub_f32 v228, 0, v228
    v_mov_b32 v229, v228
    v_mov_b32 v230, v228
    v_mov_b32 v231, v228
    v_max_f32 v232, v232, v233
    v_sub_f32 v232, 0, v232
    v_mov_b32 v233, v232
    v_mov_b32 v234, v232
    v_mov_b32 v235, v232
    v_accvgpr_write_b32 a0, 0
    v_accvgpr_write_b32 a1, 0
    v_accvgpr_write_b32 a2, 0
    v_accvgpr_write_b32 a3, 0
    v_accvgpr_write_b32 a4, 0
    v_accvgpr_write_b32 a5, 0
    v_accvgpr_write_b32 a6, 0
    v_accvgpr_write_b32 a7, 0
    v_accvgpr_write_b32 a8, 0
    v_accvgpr_write_b32 a9, 0
    v_accvgpr_write_b32 a10, 0
    v_accvgpr_write_b32 a11, 0
    v_accvgpr_write_b32 a12, 0
    v_accvgpr_write_b32 a13, 0
    v_accvgpr_write_b32 a14, 0
    v_accvgpr_write_b32 a15, 0
    v_accvgpr_write_b32 a16, 0
    v_accvgpr_write_b32 a17, 0
    v_accvgpr_write_b32 a18, 0
    v_accvgpr_write_b32 a19, 0
    v_accvgpr_write_b32 a20, 0
    v_accvgpr_write_b32 a21, 0
    v_accvgpr_write_b32 a22, 0
    v_accvgpr_write_b32 a23, 0
    v_accvgpr_write_b32 a24, 0
    v_accvgpr_write_b32 a25, 0
    v_accvgpr_write_b32 a26, 0
    v_accvgpr_write_b32 a27, 0
    v_accvgpr_write_b32 a28, 0
    v_accvgpr_write_b32 a29, 0
    v_accvgpr_write_b32 a30, 0
    v_accvgpr_write_b32 a31, 0
    v_accvgpr_write_b32 a32, 0
    v_accvgpr_write_b32 a33, 0
    v_accvgpr_write_b32 a34, 0
    v_accvgpr_write_b32 a35, 0
    v_accvgpr_write_b32 a36, 0
    v_accvgpr_write_b32 a37, 0
    v_accvgpr_write_b32 a38, 0
    v_accvgpr_write_b32 a39, 0
    v_accvgpr_write_b32 a40, 0
    v_accvgpr_write_b32 a41, 0
    v_accvgpr_write_b32 a42, 0
    v_accvgpr_write_b32 a43, 0
    v_accvgpr_write_b32 a44, 0
    v_accvgpr_write_b32 a45, 0
    v_accvgpr_write_b32 a46, 0
    v_accvgpr_write_b32 a47, 0
    v_accvgpr_write_b32 a48, 0
    v_accvgpr_write_b32 a49, 0
    v_accvgpr_write_b32 a50, 0
    v_accvgpr_write_b32 a51, 0
    v_accvgpr_write_b32 a52, 0
    v_accvgpr_write_b32 a53, 0
    v_accvgpr_write_b32 a54, 0
    v_accvgpr_write_b32 a55, 0
    v_accvgpr_write_b32 a56, 0
    v_accvgpr_write_b32 a57, 0
    v_accvgpr_write_b32 a58, 0
    v_accvgpr_write_b32 a59, 0
    v_accvgpr_write_b32 a60, 0
    v_accvgpr_write_b32 a61, 0
    v_accvgpr_write_b32 a62, 0
    v_accvgpr_write_b32 a63, 0
    v_accvgpr_write_b32 a64, 0
    v_accvgpr_write_b32 a65, 0
    v_accvgpr_write_b32 a66, 0
    v_accvgpr_write_b32 a67, 0
    v_accvgpr_write_b32 a68, 0
    v_accvgpr_write_b32 a69, 0
    v_accvgpr_write_b32 a70, 0
    v_accvgpr_write_b32 a71, 0
    v_accvgpr_write_b32 a72, 0
    v_accvgpr_write_b32 a73, 0
    v_accvgpr_write_b32 a74, 0
    v_accvgpr_write_b32 a75, 0
    v_accvgpr_write_b32 a76, 0
    v_accvgpr_write_b32 a77, 0
    v_accvgpr_write_b32 a78, 0
    v_accvgpr_write_b32 a79, 0
    v_accvgpr_write_b32 a80, 0
    v_accvgpr_write_b32 a81, 0
    v_accvgpr_write_b32 a82, 0
    v_accvgpr_write_b32 a83, 0
    v_accvgpr_write_b32 a84, 0
    v_accvgpr_write_b32 a85, 0
    v_accvgpr_write_b32 a86, 0
    v_accvgpr_write_b32 a87, 0
    v_accvgpr_write_b32 a88, 0
    v_accvgpr_write_b32 a89, 0
    v_accvgpr_write_b32 a90, 0
    v_accvgpr_write_b32 a91, 0
    v_accvgpr_write_b32 a92, 0
    v_accvgpr_write_b32 a93, 0
    v_accvgpr_write_b32 a94, 0
    v_accvgpr_write_b32 a95, 0
    v_accvgpr_write_b32 a96, 0
    v_accvgpr_write_b32 a97, 0
    v_accvgpr_write_b32 a98, 0
    v_accvgpr_write_b32 a99, 0
    v_accvgpr_write_b32 a100, 0
    v_accvgpr_write_b32 a101, 0
    v_accvgpr_write_b32 a102, 0
    v_accvgpr_write_b32 a103, 0
    v_accvgpr_write_b32 a104, 0
    v_accvgpr_write_b32 a105, 0
    v_accvgpr_write_b32 a106, 0
    v_accvgpr_write_b32 a107, 0
    v_accvgpr_write_b32 a108, 0
    v_accvgpr_write_b32 a109, 0
    v_accvgpr_write_b32 a110, 0
    v_accvgpr_write_b32 a111, 0
    v_accvgpr_write_b32 a112, 0
    v_accvgpr_write_b32 a113, 0
    v_accvgpr_write_b32 a114, 0
    v_accvgpr_write_b32 a115, 0
    v_accvgpr_write_b32 a116, 0
    v_accvgpr_write_b32 a117, 0
    v_accvgpr_write_b32 a118, 0
    v_accvgpr_write_b32 a119, 0
    v_accvgpr_write_b32 a120, 0
    v_accvgpr_write_b32 a121, 0
    v_accvgpr_write_b32 a122, 0
    v_accvgpr_write_b32 a123, 0
    v_accvgpr_write_b32 a124, 0
    v_accvgpr_write_b32 a125, 0
    v_accvgpr_write_b32 a126, 0
    v_accvgpr_write_b32 a127, 0
    v_accvgpr_write_b32 a128, 0
    v_accvgpr_write_b32 a129, 0
    v_accvgpr_write_b32 a130, 0
    v_accvgpr_write_b32 a131, 0
    v_accvgpr_write_b32 a132, 0
    v_accvgpr_write_b32 a133, 0
    v_accvgpr_write_b32 a134, 0
    v_accvgpr_write_b32 a135, 0
    v_accvgpr_write_b32 a136, 0
    v_accvgpr_write_b32 a137, 0
    v_accvgpr_write_b32 a138, 0
    v_accvgpr_write_b32 a139, 0
    v_accvgpr_write_b32 a140, 0
    v_accvgpr_write_b32 a141, 0
    v_accvgpr_write_b32 a142, 0
    v_accvgpr_write_b32 a143, 0
    v_accvgpr_write_b32 a144, 0
    v_accvgpr_write_b32 a145, 0
    v_accvgpr_write_b32 a146, 0
    v_accvgpr_write_b32 a147, 0
    v_accvgpr_write_b32 a148, 0
    v_accvgpr_write_b32 a149, 0
    v_accvgpr_write_b32 a150, 0
    v_accvgpr_write_b32 a151, 0
    v_accvgpr_write_b32 a152, 0
    v_accvgpr_write_b32 a153, 0
    v_accvgpr_write_b32 a154, 0
    v_accvgpr_write_b32 a155, 0
    v_accvgpr_write_b32 a156, 0
    v_accvgpr_write_b32 a157, 0
    v_accvgpr_write_b32 a158, 0
    v_accvgpr_write_b32 a159, 0
    v_mov_b32 v236, 0
    v_mov_b32 v237, 0
    v_mov_b32 v238, 0
    v_mov_b32 v239, 0
    v_mov_b32 v240, 0
    v_mov_b32 v241, 0
    v_mov_b32 v242, 0
    v_mov_b32 v243, 0
    v_mov_b32 v244, 0
    v_mov_b32 v245, 0
    v_mov_b32 v246, 0
    v_mov_b32 v247, 0
    v_mov_b32 v248, 0
    v_mov_b32 v249, 0
    v_mov_b32 v250, 0
    v_mov_b32 v251, 0
    v_mov_b32 v252, 0
    v_mov_b32 v253, 0
    v_mov_b32 v254, 0
    v_mov_b32 v255, 0
    s_mov_b32 s26, 0
L_slow2:
    s_add_u32 s27, s26, 4096
    s_add_u32 m0, s68, 0
    s_nop 0
    buffer_load_dwordx4 v40, s[4:7], s26 offen offset:0 nt lds
    buffer_load_dwordx4 v41, s[4:7], s26 offen offset:1024 nt lds
    buffer_load_dwordx4 v42, s[4:7], s26 offen offset:2048 nt lds
    buffer_load_dwordx4 v43, s[4:7], s26 offen offset:3072 nt lds
    s_add_u32 m0, s68, 4096
    s_nop 0
    buffer_load_dwordx4 v40, s[4:7], s27 offen offset:0 nt lds
    buffer_load_dwordx4 v41, s[4:7], s27 offen offset:1024 nt lds
    buffer_load_dwordx4 v42, s[4:7], s27 offen offset:2048 nt lds
    buffer_load_dwordx4 v43, s[4:7], s27 offen offset:3072 nt lds
    s_add_u32 m0, s68, 8192
    s_nop 0
    buffer_load_dwordx4 v44, s[8:11], s26 offen offset:0 nt lds
    buffer_load_dwordx4 v45, s[8:11], s26 offen offset:1024 nt lds
    buffer_load_dwordx4 v44, s[8:11], s26 offen offset:2048 nt lds
    buffer_load_dwordx4 v45, s[8:11], s26 offen offset:3072 nt lds
    s_add_u32 m0, s68, 12288
    s_nop 0
    buffer_load_dwordx4 v44, s[8:11], s27 offen offset:0 nt lds
    buffer_load_dwordx4 v45, s[8:11], s27 offen offset:1024 nt lds
    buffer_load_dwordx4 v44, s[8:11], s27 offen offset:2048 nt lds
    buffer_load_dwordx4 v45, s[8:11], s27 offen offset:3072 nt lds
    s_waitcnt vmcnt(0)
    ds_read_b128 v[64:67], v46 offset:0
    ds_read_b128 v[68:71], v47 offset:0
    ds_read_b128 v[72:75], v48 offset:0
    ds_read_b128 v[76:79], v49 offset:0
    ds_read_b128 v[80:83], v46 offset:4096
    ds_read_b128 v[84:87], v47 offset:4096
    ds_read_b128 v[88:91], v48 offset:4096
    ds_read_b128 v[92:95], v49 offset:4096
    s_waitcnt lgkmcnt(0)
    ds_read_b64_tr_b16 v[128:129], v50 offset:8192
    ds_read_b64_tr_b16 v[132:133], v51 offset:8192
    ds_read_b64_tr_b16 v[136:137], v52 offset:8192
    ds_read_b64_tr_b16 v[140:141], v53 offset:8192
    ds_read_b64_tr_b16 v[144:145], v54 offset:8192
    ds_read_b64_tr_b16 v[148:149], v55 offset:8192
    ds_read_b64_tr_b16 v[152:153], v56 offset:8192
    ds_read_b64_tr_b16 v[156:157], v57 offset:8192
    s_waitcnt lgkmcnt(0)
    ds_read_b64_tr_b16 v[130:131], v50 offset:12288
    ds_read_b64_tr_b16 v[134:135], v51 offset:12288
    ds_read_b64_tr_b16 v[138:139], v52 offset:12288
    ds_read_b64_tr_b16 v[142:143], v53 offset:12288
    ds_read_b64_tr_b16 v[146:147], v54 offset:12288
    ds_read_b64_tr_b16 v[150:151], v55 offset:12288
    ds_read_b64_tr_b16 v[154:155], v56 offset:12288
    ds_read_b64_tr_b16 v[158:159], v57 offset:12288
    s_waitcnt lgkmcnt(0)
    v_mfma_f32_16x16x32_bf16 v[192:195], v[64:67], a[160:163], v[216:219]
    v_mfma_f32_16x16x32_bf16 v[196:199], v[80:83], a[160:163], v[216:219]
    v_mfma_f32_16x16x32_bf16 v[192:195], v[68:71], a[164:167], v[192:195]
    v_mfma_f32_16x16x32_bf16 v[196:199], v[84:87], a[164:167], v[196:199]
    v_mfma_f32_16x16x32_bf16 v[192:195], v[72:75], a[168:171], v[192:195]
    v_mfma_f32_16x16x32_bf16 v[196:199], v[88:91], a[168:171], v[196:199]
    v_mfma_f32_16x16x32_bf16 v[192:195], v[76:79], a[172:175], v[192:195]
    v_mfma_f32_16x16x32_bf16 v[196:199], v[92:95], a[172:175], v[196:199]
    s_nop 7
    v_exp_f32 v192, v192
    v_exp_f32 v193, v193
    v_exp_f32 v194, v194
    v_exp_f32 v195, v195
    v_exp_f32 v196, v196
    v_exp_f32 v197, v197
    v_exp_f32 v198, v198
    v_exp_f32 v199, v199
    s_nop 0
    v_cvt_pk_bf16_f32 v208, v192, v193
    v_cvt_pk_bf16_f32 v209, v194, v195
    v_cvt_pk_bf16_f32 v210, v196, v197
    v_cvt_pk_bf16_f32 v211, v198, v199
    s_nop 1
    v_mfma_f32_16x16x32_bf16 a[0:3], v[128:131], v[208:211], a[0:3]
    v_mfma_f32_16x16x32_bf16 a[20:23], v[132:135], v[208:211], a[20:23]
    v_mfma_f32_16x16x32_bf16 a[40:43], v[136:139], v[208:211], a[40:43]
    v_mfma_f32_16x16x32_bf16 a[60:63], v[140:143], v[208:211], a[60:63]
    v_mfma_f32_16x16x32_bf16 a[80:83], v[144:147], v[208:211], a[80:83]
    v_mfma_f32_16x16x32_bf16 a[100:103], v[148:151], v[208:211], a[100:103]
    v_mfma_f32_16x16x32_bf16 a[120:123], v[152:155], v[208:211], a[120:123]
    v_mfma_f32_16x16x32_bf16 a[140:143], v[156:159], v[208:211], a[140:143]
    v_mfma_f32_16x16x32_bf16 v[236:239], v[60:63], v[208:211], v[236:239]
    v_mfma_f32_16x16x32_bf16 v[192:195], v[64:67], a[176:179], v[220:223]
    v_mfma_f32_16x16x32_bf16 v[196:199], v[80:83], a[176:179], v[220:223]
    v_mfma_f32_16x16x32_bf16 v[192:195], v[68:71], a[180:183], v[192:195]
    v_mfma_f32_16x16x32_bf16 v[196:199], v[84:87], a[180:183], v[196:199]
    v_mfma_f32_16x16x32_bf16 v[192:195], v[72:75], a[184:187], v[192:195]
    v_mfma_f32_16x16x32_bf16 v[196:199], v[88:91], a[184:187], v[196:199]
    v_mfma_f32_16x16x32_bf16 v[192:195], v[76:79], a[188:191], v[192:195]
    v_mfma_f32_16x16x32_bf16 v[196:199], v[92:95], a[188:191], v[196:199]
    s_nop 7
    v_exp_f32 v192, v192
    v_exp_f32 v193, v193
    v_exp_f32 v194, v194
    v_exp_f32 v195, v195
    v_exp_f32 v196, v196
    v_exp_f32 v197, v197
    v_exp_f32 v198, v198
    v_exp_f32 v199, v199
    s_nop 0
    v_cvt_pk_bf16_f32 v208, v192, v193
    v_cvt_pk_bf16_f32 v209, v194, v195
    v_cvt_pk_bf16_f32 v210, v196, v197
    v_cvt_pk_bf16_f32 v211, v198, v199
    s_nop 1
    v_mfma_f32_16x16x32_bf16 a[4:7], v[128:131], v[208:211], a[4:7]
    v_mfma_f32_16x16x32_bf16 a[24:27], v[132:135], v[208:211], a[24:27]
    v_mfma_f32_16x16x32_bf16 a[44:47], v[136:139], v[208:211], a[44:47]
    v_mfma_f32_16x16x32_bf16 a[64:67], v[140:143], v[208:211], a[64:67]
    v_mfma_f32_16x16x32_bf16 a[84:87], v[144:147], v[208:211], a[84:87]
    v_mfma_f32_16x16x32_bf16 a[104:107], v[148:151], v[208:211], a[104:107]
    v_mfma_f32_16x16x32_bf16 a[124:127], v[152:155], v[208:211], a[124:127]
    v_mfma_f32_16x16x32_bf16 a[144:147], v[156:159], v[208:211], a[144:147]
    v_mfma_f32_16x16x32_bf16 v[240:243], v[60:63], v[208:211], v[240:243]
    v_mfma_f32_16x16x32_bf16 v[192:195], v[64:67], a[192:195], v[224:227]
    v_mfma_f32_16x16x32_bf16 v[196:199], v[80:83], a[192:195], v[224:227]
    v_mfma_f32_16x16x32_bf16 v[192:195], v[68:71], a[196:199], v[192:195]
    v_mfma_f32_16x16x32_bf16 v[196:199], v[84:87], a[196:199], v[196:199]
    v_mfma_f32_16x16x32_bf16 v[192:195], v[72:75], a[200:203], v[192:195]
    v_mfma_f32_16x16x32_bf16 v[196:199], v[88:91], a[200:203], v[196:199]
    v_mfma_f32_16x16x32_bf16 v[192:195], v[76:79], a[204:207], v[192:195]
    v_mfma_f32_16x16x32_bf16 v[196:199], v[92:95], a[204:207], v[196:199]
    s_nop 7
    v_exp_f32 v192, v192
    v_exp_f32 v193, v193
    v_exp_f32 v194, v194
    v_exp_f32 v195, v195
    v_exp_f32 v196, v196
    v_exp_f32 v197, v197
    v_exp_f32 v198, v198
    v_exp_f32 v199, v199
    s_nop 0
    v_cvt_pk_bf16_f32 v208, v192, v193
    v_cvt_pk_bf16_f32 v209, v194, v195
    v_cvt_pk_bf16_f32 v210, v196, v197
    v_cvt_pk_bf16_f32 v211, v198, v199
    s_nop 1
    v_mfma_f32_16x16x32_bf16 a[8:11], v[128:131], v[208:211], a[8:11]
    v_mfma_f32_16x16x32_bf16 a[28:31], v[132:135], v[208:211], a[28:31]
    v_mfma_f32_16x16x32_bf16 a[48:51], v[136:139], v[208:211], a[48:51]
    v_mfma_f32_16x16x32_bf16 a[68:71], v[140:143], v[208:211], a[68:71]
    v_mfma_f32_16x16x32_bf16 a[88:91], v[144:147], v[208:211], a[88:91]
    v_mfma_f32_16x16x32_bf16 a[108:111], v[148:151], v[208:211], a[108:111]
    v_mfma_f32_16x16x32_bf16 a[128:131], v[152:155], v[208:211], a[128:131]
    v_mfma_f32_16x16x32_bf16 a[148:151], v[156:159], v[208:211], a[148:151]
    v_mfma_f32_16x16x32_bf16 v[244:247], v[60:63], v[208:211], v[244:247]
    v_mfma_f32_16x16x32_bf16 v[192:195], v[64:67], a[208:211], v[228:231]
    v_mfma_f32_16x16x32_bf16 v[196:199], v[80:83], a[208:211], v[228:231]
    v_mfma_f32_16x16x32_bf16 v[192:195], v[68:71], a[212:215], v[192:195]
    v_mfma_f32_16x16x32_bf16 v[196:199], v[84:87], a[212:215], v[196:199]
    v_mfma_f32_16x16x32_bf16 v[192:195], v[72:75], a[216:219], v[192:195]
    v_mfma_f32_16x16x32_bf16 v[196:199], v[88:91], a[216:219], v[196:199]
    v_mfma_f32_16x16x32_bf16 v[192:195], v[76:79], a[220:223], v[192:195]
    v_mfma_f32_16x16x32_bf16 v[196:199], v[92:95], a[220:223], v[196:199]
    s_nop 7
    v_exp_f32 v192, v192
    v_exp_f32 v193, v193
    v_exp_f32 v194, v194
    v_exp_f32 v195, v195
    v_exp_f32 v196, v196
    v_exp_f32 v197, v197
    v_exp_f32 v198, v198
    v_exp_f32 v199, v199
    s_nop 0
    v_cvt_pk_bf16_f32 v208, v192, v193
    v_cvt_pk_bf16_f32 v209, v194, v195
    v_cvt_pk_bf16_f32 v210, v196, v197
    v_cvt_pk_bf16_f32 v211, v198, v199
    s_nop 1
    v_mfma_f32_16x16x32_bf16 a[12:15], v[128:131], v[208:211], a[12:15]
    v_mfma_f32_16x16x32_bf16 a[32:35], v[132:135], v[208:211], a[32:35]
    v_mfma_f32_16x16x32_bf16 a[52:55], v[136:139], v[208:211], a[52:55]
    v_mfma_f32_16x16x32_bf16 a[72:75], v[140:143], v[208:211], a[72:75]
    v_mfma_f32_16x16x32_bf16 a[92:95], v[144:147], v[208:211], a[92:95]
    v_mfma_f32_16x16x32_bf16 a[112:115], v[148:151], v[208:211], a[112:115]
    v_mfma_f32_16x16x32_bf16 a[132:135], v[152:155], v[208:211], a[132:135]
    v_mfma_f32_16x16x32_bf16 a[152:155], v[156:159], v[208:211], a[152:155]
    v_mfma_f32_16x16x32_bf16 v[248:251], v[60:63], v[208:211], v[248:251]
    v_mfma_f32_16x16x32_bf16 v[192:195], v[64:67], a[224:227], v[232:235]
    v_mfma_f32_16x16x32_bf16 v[196:199], v[80:83], a[224:227], v[232:235]
    v_mfma_f32_16x16x32_bf16 v[192:195], v[68:71], a[228:231], v[192:195]
    v_mfma_f32_16x16x32_bf16 v[196:199], v[84:87], a[228:231], v[196:199]
    v_mfma_f32_16x16x32_bf16 v[192:195], v[72:75], a[232:235], v[192:195]
    v_mfma_f32_16x16x32_bf16 v[196:199], v[88:91], a[232:235], v[196:199]
    v_mfma_f32_16x16x32_bf16 v[192:195], v[76:79], a[236:239], v[192:195]
    v_mfma_f32_16x16x32_bf16 v[196:199], v[92:95], a[236:239], v[196:199]
    s_nop 7
    v_exp_f32 v192, v192
    v_exp_f32 v193, v193
    v_exp_f32 v194, v194
    v_exp_f32 v195, v195
    v_exp_f32 v196, v196
    v_exp_f32 v197, v197
    v_exp_f32 v198, v198
    v_exp_f32 v199, v199
    s_nop 0
    v_cvt_pk_bf16_f32 v208, v192, v193
    v_cvt_pk_bf16_f32 v209, v194, v195
    v_cvt_pk_bf16_f32 v210, v196, v197
    v_cvt_pk_bf16_f32 v211, v198, v199
    s_nop 1
    v_mfma_f32_16x16x32_bf16 a[16:19], v[128:131], v[208:211], a[16:19]
    v_mfma_f32_16x16x32_bf16 a[36:39], v[132:135], v[208:211], a[36:39]
    v_mfma_f32_16x16x32_bf16 a[56:59], v[136:139], v[208:211], a[56:59]
    v_mfma_f32_16x16x32_bf16 a[76:79], v[140:143], v[208:211], a[76:79]
    v_mfma_f32_16x16x32_bf16 a[96:99], v[144:147], v[208:211], a[96:99]
    v_mfma_f32_16x16x32_bf16 a[116:119], v[148:151], v[208:211], a[116:119]
    v_mfma_f32_16x16x32_bf16 a[136:139], v[152:155], v[208:211], a[136:139]
    v_mfma_f32_16x16x32_bf16 a[156:159], v[156:159], v[208:211], a[156:159]
    v_mfma_f32_16x16x32_bf16 v[252:255], v[60:63], v[208:211], v[252:255]
    s_add_u32 s26, s26, 8192
    s_cmp_lt_u32 s26, 131072
    s_cbranch_scc1 L_slow2
    s_nop 7
L_ok:
    v_add_u32 v38, s68, v33
    v_xor_b32 v39, 32768, v38
    v_mov_b32 v40, v216
    v_mov_b32 v45, v236
    v_mov_b32 v41, v220
    v_mov_b32 v46, v240
    v_mov_b32 v42, v224
    v_mov_b32 v47, v244
    v_mov_b32 v43, v228
    v_mov_b32 v48, v248
    v_mov_b32 v44, v232
    v_mov_b32 v49, v252
    ds_write_b128 v38, v[40:43] offset:20480
    ds_write_b128 v38, v[44:47] offset:21504
    ds_write_b128 v38, v[48:51] offset:22528
    ds_write_b128 v38, a[80:83] offset:0
    ds_write_b128 v38, a[84:87] offset:1024
    ds_write_b128 v38, a[88:91] offset:2048
    ds_write_b128 v38, a[92:95] offset:3072
    ds_write_b128 v38, a[96:99] offset:4096
    ds_write_b128 v38, a[100:103] offset:5120
    ds_write_b128 v38, a[104:107] offset:6144
    ds_write_b128 v38, a[108:111] offset:7168
    ds_write_b128 v38, a[112:115] offset:8192
    ds_write_b128 v38, a[116:119] offset:9216
    ds_write_b128 v38, a[120:123] offset:10240
    ds_write_b128 v38, a[124:127] offset:11264
    ds_write_b128 v38, a[128:131] offset:12288
    ds_write_b128 v38, a[132:135] offset:13312
    ds_write_b128 v38, a[136:139] offset:14336
    ds_write_b128 v38, a[140:143] offset:15360
    ds_write_b128 v38, a[144:147] offset:16384
    ds_write_b128 v38, a[148:151] offset:17408
    ds_write_b128 v38, a[152:155] offset:18432
    ds_write_b128 v38, a[156:159] offset:19456
    v_accvgpr_read_b32 v164, a0
    v_accvgpr_read_b32 v165, a1
    v_accvgpr_read_b32 v166, a2
    v_accvgpr_read_b32 v167, a3
    v_accvgpr_read_b32 v168, a4
    v_accvgpr_read_b32 v169, a5
    v_accvgpr_read_b32 v170, a6
    v_accvgpr_read_b32 v171, a7
    v_accvgpr_read_b32 v172, a8
    v_accvgpr_read_b32 v173, a9
    v_accvgpr_read_b32 v174, a10
    v_accvgpr_read_b32 v175, a11
    v_accvgpr_read_b32 v176, a12
    v_accvgpr_read_b32 v177, a13
    v_accvgpr_read_b32 v178, a14
    v_accvgpr_read_b32 v179, a15
    v_accvgpr_read_b32 v180, a16
    v_accvgpr_read_b32 v181, a17
    v_accvgpr_read_b32 v182, a18
    v_accvgpr_read_b32 v183, a19
    v_accvgpr_read_b32 v184, a20
    v_accvgpr_read_b32 v185, a21
    v_accvgpr_read_b32 v186, a22
    v_accvgpr_read_b32 v187, a23
    v_accvgpr_read_b32 v188, a24
    v_accvgpr_read_b32 v189, a25
    v_accvgpr_read_b32 v190, a26
    v_accvgpr_read_b32 v191, a27
    v_accvgpr_read_b32 v192, a28
    v_accvgpr_read_b32 v193, a29
    v_accvgpr_read_b32 v194, a30
    v_accvgpr_read_b32 v195, a31
    v_accvgpr_read_b32 v196, a32
    v_accvgpr_read_b32 v197, a33
    v_accvgpr_read_b32 v198, a34
    v_accvgpr_read_b32 v199, a35
    v_accvgpr_read_b32 v200, a36
    v_accvgpr_read_b32 v201, a37
    v_accvgpr_read_b32 v202, a38
    v_accvgpr_read_b32 v203, a39
    v_accvgpr_read_b32 v204, a40
    v_accvgpr_read_b32 v205, a41
    v_accvgpr_read_b32 v206, a42
    v_accvgpr_read_b32 v207, a43
    v_accvgpr_read_b32 v208, a44
    v_accvgpr_read_b32 v209, a45
    v_accvgpr_read_b32 v210, a46
    v_accvgpr_read_b32 v211, a47
    v_accvgpr_read_b32 v212, a48
    v_accvgpr_read_b32 v213, a49
    v_accvgpr_read_b32 v214, a50
    v_accvgpr_read_b32 v215, a51
    v_accvgpr_read_b32 v216, a52
    v_accvgpr_read_b32 v217, a53
    v_accvgpr_read_b32 v218, a54
    v_accvgpr_read_b32 v219, a55
    v_accvgpr_read_b32 v220, a56
    v_accvgpr_read_b32 v221, a57
    v_accvgpr_read_b32 v222, a58
    v_accvgpr_read_b32 v223, a59
    v_accvgpr_read_b32 v224, a60
    v_accvgpr_read_b32 v225, a61
    v_accvgpr_read_b32 v226, a62
    v_accvgpr_read_b32 v227, a63
    v_accvgpr_read_b32 v228, a64
    v_accvgpr_read_b32 v229, a65
    v_accvgpr_read_b32 v230, a66
    v_accvgpr_read_b32 v231, a67
    v_accvgpr_read_b32 v232, a68
    v_accvgpr_read_b32 v233, a69
    v_accvgpr_read_b32 v234, a70
    v_accvgpr_read_b32 v235, a71
    v_accvgpr_read_b32 v236, a72
    v_accvgpr_read_b32 v237, a73
    v_accvgpr_read_b32 v238, a74
    v_accvgpr_read_b32 v239, a75
    v_accvgpr_read_b32 v240, a76
    v_accvgpr_read_b32 v241, a77
    v_accvgpr_read_b32 v242, a78
    v_accvgpr_read_b32 v243, a79
    s_waitcnt lgkmcnt(0)
    s_barrier
    ds_read_b128 v[52:55], v39 offset:20480
    ds_read_b128 v[56:59], v39 offset:21504
    ds_read_b128 v[60:63], v39 offset:22528
    ds_read_b128 v[64:67], v39 offset:0
    ds_read_b128 v[68:71], v39 offset:1024
    ds_read_b128 v[72:75], v39 offset:2048
    ds_read_b128 v[76:79], v39 offset:3072
    ds_read_b128 v[80:83], v39 offset:4096
    ds_read_b128 v[84:87], v39 offset:5120
    ds_read_b128 v[88:91], v39 offset:6144
    ds_read_b128 v[92:95], v39 offset:7168
    ds_read_b128 v[96:99], v39 offset:8192
    ds_read_b128 v[100:103], v39 offset:9216
    ds_read_b128 v[104:107], v39 offset:10240
    ds_read_b128 v[108:111], v39 offset:11264
    ds_read_b128 v[112:115], v39 offset:12288
    ds_read_b128 v[116:119], v39 offset:13312
    ds_read_b128 v[120:123], v39 offset:14336
    ds_read_b128 v[124:127], v39 offset:15360
    ds_read_b128 v[128:131], v39 offset:16384
    ds_read_b128 v[132:135], v39 offset:17408
    ds_read_b128 v[136:139], v39 offset:18432
    ds_read_b128 v[140:143], v39 offset:19456
    s_waitcnt lgkmcnt(15)
    v_min_f32 v244, v40, v52
    v_min_f32 v245, v41, v53
    v_min_f32 v246, v42, v54
    v_min_f32 v247, v43, v55
    v_min_f32 v248, v44, v56
    v_sub_f32 v144, v244, v40
    v_sub_f32 v154, v244, v52
    v_sub_f32 v146, v245, v41
    v_sub_f32 v156, v245, v53
    v_sub_f32 v148, v246, v42
    v_sub_f32 v158, v246, v54
    v_sub_f32 v150, v247, v43
    v_sub_f32 v160, v247, v55
    v_sub_f32 v152, v248, v44
    v_sub_f32 v162, v248, v56
    v_exp_f32 v144, v144
    v_exp_f32 v154, v154
    v_exp_f32 v146, v146
    v_exp_f32 v156, v156
    v_exp_f32 v148, v148
    v_exp_f32 v158, v158
    v_exp_f32 v150, v150
    v_exp_f32 v160, v160
    v_exp_f32 v152, v152
    v_exp_f32 v162, v162
    s_nop 0
    v_mul_f32 v244, v144, v45
    v_fma_f32 v244, v154, v57, v244
    v_mul_f32 v245, v146, v46
    v_fma_f32 v245, v156, v58, v245
    v_mul_f32 v246, v148, v47
    v_fma_f32 v246, v158, v59, v246
    v_mul_f32 v247, v150, v48
    v_fma_f32 v247, v160, v60, v247
    v_mul_f32 v248, v152, v49
    v_fma_f32 v248, v162, v61, v248
    v_rcp_f32 v244, v244
    v_rcp_f32 v245, v245
    v_rcp_f32 v246, v246
    v_rcp_f32 v247, v247
    v_rcp_f32 v248, v248
    s_nop 0
    v_mul_f32 v144, v144, v244
    v_mul_f32 v154, v154, v244
    v_mul_f32 v146, v146, v245
    v_mul_f32 v156, v156, v245
    v_mul_f32 v148, v148, v246
    v_mul_f32 v158, v158, v246
    v_mul_f32 v150, v150, v247
    v_mul_f32 v160, v160, v247
    v_mul_f32 v152, v152, v248
    v_mul_f32 v162, v162, v248
    v_mov_b32 v145, v144
    v_mov_b32 v155, v154
    v_mov_b32 v147, v146
    v_mov_b32 v157, v156
    v_mov_b32 v149, v148
    v_mov_b32 v159, v158
    v_mov_b32 v151, v150
    v_mov_b32 v161, v160
    v_mov_b32 v153, v152
    v_mov_b32 v163, v162
    s_waitcnt lgkmcnt(0)
    s_add_u32 m0, s67, 0
    s_xor_b32 s29, s73, 1
    s_and_b32 s30, s29, 1
    s_lshl_b32 s30, s30, 17
    s_lshr_b32 s29, s29, 1
    s_lshl_b32 s29, s29, 6
    s_add_u32 s29, s29, s30
    buffer_load_dwordx4 v16, s[84:87], s29 offen offset:0 lds
    v_pk_mul_f32 v[164:165], v[164:165], v[144:145]
    v_pk_mul_f32 v[166:167], v[166:167], v[144:145]
    v_pk_fma_f32 v[164:165], v[64:65], v[154:155], v[164:165]
    v_pk_fma_f32 v[166:167], v[66:67], v[154:155], v[166:167]
    v_cvt_pk_bf16_f32 v8, v164, v165
    v_cvt_pk_bf16_f32 v9, v166, v167
    buffer_load_dwordx4 v17, s[84:87], s29 offen offset:1024 lds
    v_pk_mul_f32 v[184:185], v[184:185], v[144:145]
    v_pk_mul_f32 v[186:187], v[186:187], v[144:145]
    v_pk_fma_f32 v[184:185], v[84:85], v[154:155], v[184:185]
    v_pk_fma_f32 v[186:187], v[86:87], v[154:155], v[186:187]
    v_cvt_pk_bf16_f32 v10, v184, v185
    v_cvt_pk_bf16_f32 v11, v186, v187
    ds_write_b128 v39, v[8:11] offset:0
    buffer_load_dwordx4 v18, s[84:87], s29 offen offset:2048 lds
    v_pk_mul_f32 v[168:169], v[168:169], v[146:147]
    v_pk_mul_f32 v[170:171], v[170:171], v[146:147]
    v_pk_fma_f32 v[168:169], v[68:69], v[156:157], v[168:169]
    v_pk_fma_f32 v[170:171], v[70:71], v[156:157], v[170:171]
    v_cvt_pk_bf16_f32 v12, v168, v169
    v_cvt_pk_bf16_f32 v13, v170, v171
    buffer_load_dwordx4 v19, s[84:87], s29 offen offset:3072 lds
    v_pk_mul_f32 v[188:189], v[188:189], v[146:147]
    v_pk_mul_f32 v[190:191], v[190:191], v[146:147]
    v_pk_fma_f32 v[188:189], v[88:89], v[156:157], v[188:189]
    v_pk_fma_f32 v[190:191], v[90:91], v[156:157], v[190:191]
    v_cvt_pk_bf16_f32 v14, v188, v189
    v_cvt_pk_bf16_f32 v15, v190, v191
    ds_write_b128 v39, v[12:15] offset:1024
    s_add_u32 m0, s67, 4096
    s_add_u32 s29, s29, 65536
    buffer_load_dwordx4 v16, s[84:87], s29 offen offset:0 lds
    v_pk_mul_f32 v[172:173], v[172:173], v[148:149]
    v_pk_mul_f32 v[174:175], v[174:175], v[148:149]
    v_pk_fma_f32 v[172:173], v[72:73], v[158:159], v[172:173]
    v_pk_fma_f32 v[174:175], v[74:75], v[158:159], v[174:175]
    v_cvt_pk_bf16_f32 v8, v172, v173
    v_cvt_pk_bf16_f32 v9, v174, v175
    buffer_load_dwordx4 v17, s[84:87], s29 offen offset:1024 lds
    v_pk_mul_f32 v[192:193], v[192:193], v[148:149]
    v_pk_mul_f32 v[194:195], v[194:195], v[148:149]
    v_pk_fma_f32 v[192:193], v[92:93], v[158:159], v[192:193]
    v_pk_fma_f32 v[194:195], v[94:95], v[158:159], v[194:195]
    v_cvt_pk_bf16_f32 v10, v192, v193
    v_cvt_pk_bf16_f32 v11, v194, v195
    ds_write_b128 v39, v[8:11] offset:2048
    buffer_load_dwordx4 v18, s[84:87], s29 offen offset:2048 lds
    v_pk_mul_f32 v[176:177], v[176:177], v[150:151]
    v_pk_mul_f32 v[178:179], v[178:179], v[150:151]
    v_pk_fma_f32 v[176:177], v[76:77], v[160:161], v[176:177]
    v_pk_fma_f32 v[178:179], v[78:79], v[160:161], v[178:179]
    v_cvt_pk_bf16_f32 v12, v176, v177
    v_cvt_pk_bf16_f32 v13, v178, v179
    buffer_load_dwordx4 v19, s[84:87], s29 offen offset:3072 lds
    v_pk_mul_f32 v[196:197], v[196:197], v[150:151]
    v_pk_mul_f32 v[198:199], v[198:199], v[150:151]
    v_pk_fma_f32 v[196:197], v[96:97], v[160:161], v[196:197]
    v_pk_fma_f32 v[198:199], v[98:99], v[160:161], v[198:199]
    v_cvt_pk_bf16_f32 v14, v196, v197
    v_cvt_pk_bf16_f32 v15, v198, v199
    ds_write_b128 v39, v[12:15] offset:3072
    s_add_u32 m0, s67, 8192
    s_xor_b32 s29, s73, 2
    s_and_b32 s30, s29, 1
    s_lshl_b32 s30, s30, 17
    s_lshr_b32 s29, s29, 1
    s_lshl_b32 s29, s29, 6
    s_add_u32 s29, s29, s30
    buffer_load_dwordx4 v16, s[84:87], s29 offen offset:0 lds
    v_pk_mul_f32 v[180:181], v[180:181], v[152:153]
    v_pk_mul_f32 v[182:183], v[182:183], v[152:153]
    v_pk_fma_f32 v[180:181], v[80:81], v[162:163], v[180:181]
    v_pk_fma_f32 v[182:183], v[82:83], v[162:163], v[182:183]
    v_cvt_pk_bf16_f32 v8, v180, v181
    v_cvt_pk_bf16_f32 v9, v182, v183
    buffer_load_dwordx4 v17, s[84:87], s29 offen offset:1024 lds
    v_pk_mul_f32 v[200:201], v[200:201], v[152:153]
    v_pk_mul_f32 v[202:203], v[202:203], v[152:153]
    v_pk_fma_f32 v[200:201], v[100:101], v[162:163], v[200:201]
    v_pk_fma_f32 v[202:203], v[102:103], v[162:163], v[202:203]
    v_cvt_pk_bf16_f32 v10, v200, v201
    v_cvt_pk_bf16_f32 v11, v202, v203
    ds_write_b128 v39, v[8:11] offset:4096
    buffer_load_dwordx4 v18, s[84:87], s29 offen offset:2048 lds
    v_pk_mul_f32 v[204:205], v[204:205], v[144:145]
    v_pk_mul_f32 v[206:207], v[206:207], v[144:145]
    v_pk_fma_f32 v[204:205], v[104:105], v[154:155], v[204:205]
    v_pk_fma_f32 v[206:207], v[106:107], v[154:155], v[206:207]
    v_cvt_pk_bf16_f32 v12, v204, v205
    v_cvt_pk_bf16_f32 v13, v206, v207
    buffer_load_dwordx4 v19, s[84:87], s29 offen offset:3072 lds
    v_pk_mul_f32 v[224:225], v[224:225], v[144:145]
    v_pk_mul_f32 v[226:227], v[226:227], v[144:145]
    v_pk_fma_f32 v[224:225], v[124:125], v[154:155], v[224:225]
    v_pk_fma_f32 v[226:227], v[126:127], v[154:155], v[226:227]
    v_cvt_pk_bf16_f32 v14, v224, v225
    v_cvt_pk_bf16_f32 v15, v226, v227
    ds_write_b128 v39, v[12:15] offset:5120
    s_add_u32 m0, s67, 12288
    s_add_u32 s29, s29, 65536
    buffer_load_dwordx4 v16, s[84:87], s29 offen offset:0 lds
    v_pk_mul_f32 v[208:209], v[208:209], v[146:147]
    v_pk_mul_f32 v[210:211], v[210:211], v[146:147]
    v_pk_fma_f32 v[208:209], v[108:109], v[156:157], v[208:209]
    v_pk_fma_f32 v[210:211], v[110:111], v[156:157], v[210:211]
    v_cvt_pk_bf16_f32 v8, v208, v209
    v_cvt_pk_bf16_f32 v9, v210, v211
    buffer_load_dwordx4 v17, s[84:87], s29 offen offset:1024 lds
    v_pk_mul_f32 v[228:229], v[228:229], v[146:147]
    v_pk_mul_f32 v[230:231], v[230:231], v[146:147]
    v_pk_fma_f32 v[228:229], v[128:129], v[156:157], v[228:229]
    v_pk_fma_f32 v[230:231], v[130:131], v[156:157], v[230:231]
    v_cvt_pk_bf16_f32 v10, v228, v229
    v_cvt_pk_bf16_f32 v11, v230, v231
    ds_write_b128 v39, v[8:11] offset:6144
    buffer_load_dwordx4 v18, s[84:87], s29 offen offset:2048 lds
    v_pk_mul_f32 v[212:213], v[212:213], v[148:149]
    v_pk_mul_f32 v[214:215], v[214:215], v[148:149]
    v_pk_fma_f32 v[212:213], v[112:113], v[158:159], v[212:213]
    v_pk_fma_f32 v[214:215], v[114:115], v[158:159], v[214:215]
    v_cvt_pk_bf16_f32 v12, v212, v213
    v_cvt_pk_bf16_f32 v13, v214, v215
    buffer_load_dwordx4 v19, s[84:87], s29 offen offset:3072 lds
    v_pk_mul_f32 v[232:233], v[232:233], v[148:149]
    v_pk_mul_f32 v[234:235], v[234:235], v[148:149]
    v_pk_fma_f32 v[232:233], v[132:133], v[158:159], v[232:233]
    v_pk_fma_f32 v[234:235], v[134:135], v[158:159], v[234:235]
    v_cvt_pk_bf16_f32 v14, v232, v233
    v_cvt_pk_bf16_f32 v15, v234, v235
    ds_write_b128 v39, v[12:15] offset:7168
    v_pk_mul_f32 v[216:217], v[216:217], v[150:151]
    v_pk_mul_f32 v[218:219], v[218:219], v[150:151]
    v_pk_fma_f32 v[216:217], v[116:117], v[160:161], v[216:217]
    v_pk_fma_f32 v[218:219], v[118:119], v[160:161], v[218:219]
    v_cvt_pk_bf16_f32 v8, v216, v217
    v_cvt_pk_bf16_f32 v9, v218, v219
    v_pk_mul_f32 v[236:237], v[236:237], v[150:151]
    v_pk_mul_f32 v[238:239], v[238:239], v[150:151]
    v_pk_fma_f32 v[236:237], v[136:137], v[160:161], v[236:237]
    v_pk_fma_f32 v[238:239], v[138:139], v[160:161], v[238:239]
    v_cvt_pk_bf16_f32 v10, v236, v237
    v_cvt_pk_bf16_f32 v11, v238, v239
    ds_write_b128 v39, v[8:11] offset:8192
    v_pk_mul_f32 v[220:221], v[220:221], v[152:153]
    v_pk_mul_f32 v[222:223], v[222:223], v[152:153]
    v_pk_fma_f32 v[220:221], v[120:121], v[162:163], v[220:221]
    v_pk_fma_f32 v[222:223], v[122:123], v[162:163], v[222:223]
    v_cvt_pk_bf16_f32 v12, v220, v221
    v_cvt_pk_bf16_f32 v13, v222, v223
    v_pk_mul_f32 v[240:241], v[240:241], v[152:153]
    v_pk_mul_f32 v[242:243], v[242:243], v[152:153]
    v_pk_fma_f32 v[240:241], v[140:141], v[162:163], v[240:241]
    v_pk_fma_f32 v[242:243], v[142:143], v[162:163], v[242:243]
    v_cvt_pk_bf16_f32 v14, v240, v241
    v_cvt_pk_bf16_f32 v15, v242, v243
    ds_write_b128 v39, v[12:15] offset:9216
    s_and_b32 s29, s73, 1
    s_lshl_b32 s29, s29, 16
    v_add_u32 v38, s29, v33
    v_xor_b32 v39, 65536, v38
    s_lshl_b32 s29, s64, 3
    s_add_u32 s69, s29, s63
    s_mul_i32 s29, s69, 1310720
    s_add_u32 s29, s29, 0
    s_add_u32 s92, s60, s29
    s_addc_u32 s93, s61, 0
    s_and_b32 s93, s93, 0xffff
    s_mov_b32 s94, 1310720
    s_mov_b32 s95, 0x20000
    s_lshr_b32 s70, s62, 1
    s_mul_i32 s71, s70, 5120
    s_mul_i32 s29, s24, 327680
    s_add_u32 s71, s71, s29
    s_waitcnt lgkmcnt(0)
    s_barrier
    ds_read_b128 a[0:3], v38 offset:32768
    ds_read_b128 a[4:7], v38 offset:33792
    ds_read_b128 a[8:11], v38 offset:34816
    ds_read_b128 a[12:15], v38 offset:35840
    ds_read_b128 a[16:19], v38 offset:36864
    ds_read_b128 a[20:23], v38 offset:37888
    ds_read_b128 a[24:27], v38 offset:38912
    ds_read_b128 a[28:31], v38 offset:39936
    ds_read_b128 a[32:35], v38 offset:40960
    ds_read_b128 a[36:39], v38 offset:41984
    ds_read_b128 a[40:43], v38 offset:0
    ds_read_b128 a[44:47], v38 offset:1024
    ds_read_b128 a[48:51], v38 offset:2048
    ds_read_b128 a[52:55], v38 offset:3072
    ds_read_b128 a[56:59], v38 offset:4096
    ds_read_b128 a[60:63], v38 offset:5120
    ds_read_b128 a[64:67], v38 offset:6144
    ds_read_b128 a[68:71], v38 offset:7168
    ds_read_b128 a[72:75], v38 offset:8192
    ds_read_b128 a[76:79], v38 offset:9216
    s_waitcnt vmcnt(16)
    ds_read_b64_tr_b16 v[64:65], v20 offset:0
    ds_read_b64_tr_b16 v[66:67], v20 offset:1024
    ds_read_b64_tr_b16 v[68:69], v21 offset:0
    ds_read_b64_tr_b16 v[70:71], v21 offset:1024
    ds_read_b64_tr_b16 v[72:73], v20 offset:2048
    ds_read_b64_tr_b16 v[74:75], v20 offset:3072
    ds_read_b64_tr_b16 v[76:77], v21 offset:2048
    ds_read_b64_tr_b16 v[78:79], v21 offset:3072
    ds_read_b64_tr_b16 v[80:81], v20 offset:4096
    ds_read_b64_tr_b16 v[82:83], v20 offset:5120
    ds_read_b64_tr_b16 v[84:85], v21 offset:4096
    ds_read_b64_tr_b16 v[86:87], v21 offset:5120
    ds_read_b64_tr_b16 v[88:89], v20 offset:6144
    ds_read_b64_tr_b16 v[90:91], v20 offset:7168
    ds_read_b64_tr_b16 v[92:93], v21 offset:6144
    ds_read_b64_tr_b16 v[94:95], v21 offset:7168
    s_waitcnt vmcnt(8)
    s_waitcnt lgkmcnt(0)
    v_mfma_f32_16x16x32_bf16 v[128:131], v[64:67], a[0:3], 0
    s_add_u32 m0, s74, 0
    s_xor_b32 s29, s73, 3
    s_and_b32 s30, s29, 1
    s_lshl_b32 s30, s30, 17
    s_lshr_b32 s29, s29, 1
    s_lshl_b32 s29, s29, 6
    s_add_u32 s29, s29, s30
    buffer_load_dwordx4 v16, s[84:87], s29 offen offset:0 lds
    v_mfma_f32_16x16x32_bf16 v[148:151], v[68:71], a[0:3], 0
    v_mfma_f32_16x16x32_bf16 v[132:135], v[64:67], a[4:7], 0
    buffer_load_dwordx4 v17, s[84:87], s29 offen offset:1024 lds
    v_mfma_f32_16x16x32_bf16 v[152:155], v[68:71], a[4:7], 0
    buffer_load_dwordx4 v18, s[84:87], s29 offen offset:2048 lds
    v_mfma_f32_16x16x32_bf16 v[136:139], v[64:67], a[8:11], 0
    v_mfma_f32_16x16x32_bf16 v[156:159], v[68:71], a[8:11], 0
    buffer_load_dwordx4 v19, s[84:87], s29 offen offset:3072 lds
    v_mfma_f32_16x16x32_bf16 v[140:143], v[64:67], a[12:15], 0
    s_add_u32 m0, s74, 4096
    s_add_u32 s29, s29, 65536
    buffer_load_dwordx4 v16, s[84:87], s29 offen offset:0 lds
    v_mfma_f32_16x16x32_bf16 v[160:163], v[68:71], a[12:15], 0
    v_mfma_f32_16x16x32_bf16 v[144:147], v[64:67], a[16:19], 0
    buffer_load_dwordx4 v17, s[84:87], s29 offen offset:1024 lds
    v_mfma_f32_16x16x32_bf16 v[164:167], v[68:71], a[16:19], 0
    buffer_load_dwordx4 v18, s[84:87], s29 offen offset:2048 lds
    v_mfma_f32_16x16x32_bf16 v[128:131], v[72:75], a[20:23], v[128:131]
    v_mfma_f32_16x16x32_bf16 v[148:151], v[76:79], a[20:23], v[148:151]
    buffer_load_dwordx4 v19, s[84:87], s29 offen offset:3072 lds
    v_mfma_f32_16x16x32_bf16 v[132:135], v[72:75], a[24:27], v[132:135]
    ds_read_b128 a[80:83], v39 offset:32768
    v_mfma_f32_16x16x32_bf16 v[152:155], v[76:79], a[24:27], v[152:155]
    ds_read_b128 a[84:87], v39 offset:33792
    v_mfma_f32_16x16x32_bf16 v[136:139], v[72:75], a[28:31], v[136:139]
    ds_read_b128 a[88:91], v39 offset:34816
    ds_read_b128 a[92:95], v39 offset:35840
    v_mfma_f32_16x16x32_bf16 v[156:159], v[76:79], a[28:31], v[156:159]
    ds_read_b128 a[96:99], v39 offset:36864
    v_mfma_f32_16x16x32_bf16 v[140:143], v[72:75], a[32:35], v[140:143]
    ds_read_b128 a[100:103], v39 offset:37888
    v_mfma_f32_16x16x32_bf16 v[160:163], v[76:79], a[32:35], v[160:163]
    ds_read_b128 a[104:107], v39 offset:38912
    v_mfma_f32_16x16x32_bf16 v[144:147], v[72:75], a[36:39], v[144:147]
    ds_read_b128 a[108:111], v39 offset:39936
    ds_read_b128 a[112:115], v39 offset:40960
    v_mfma_f32_16x16x32_bf16 v[164:167], v[76:79], a[36:39], v[164:167]
    ds_read_b128 a[116:119], v39 offset:41984
    v_mfma_f32_16x16x32_bf16 v[128:131], v[80:83], a[40:43], v[128:131]
    ds_read_b128 a[120:123], v39 offset:0
    v_mfma_f32_16x16x32_bf16 v[148:151], v[84:87], a[40:43], v[148:151]
    ds_read_b128 a[124:127], v39 offset:1024
    ds_read_b128 a[128:131], v39 offset:2048
    v_mfma_f32_16x16x32_bf16 v[132:135], v[80:83], a[44:47], v[132:135]
    ds_read_b128 a[132:135], v39 offset:3072
    v_mfma_f32_16x16x32_bf16 v[152:155], v[84:87], a[44:47], v[152:155]
    ds_read_b128 a[136:139], v39 offset:4096
    v_mfma_f32_16x16x32_bf16 v[136:139], v[80:83], a[48:51], v[136:139]
    ds_read_b128 a[140:143], v39 offset:5120
    ds_read_b128 a[144:147], v39 offset:6144
    v_mfma_f32_16x16x32_bf16 v[156:159], v[84:87], a[48:51], v[156:159]
    ds_read_b128 a[148:151], v39 offset:7168
    v_mfma_f32_16x16x32_bf16 v[140:143], v[80:83], a[52:55], v[140:143]
    ds_read_b128 a[152:155], v39 offset:8192
    v_mfma_f32_16x16x32_bf16 v[160:163], v[84:87], a[52:55], v[160:163]
    ds_read_b128 a[156:159], v39 offset:9216
    v_mfma_f32_16x16x32_bf16 v[144:147], v[80:83], a[56:59], v[144:147]
    ds_read_b64_tr_b16 v[96:97], v22 offset:0
    ds_read_b64_tr_b16 v[98:99], v22 offset:1024
    v_mfma_f32_16x16x32_bf16 v[164:167], v[84:87], a[56:59], v[164:167]
    ds_read_b64_tr_b16 v[100:101], v23 offset:0
    v_mfma_f32_16x16x32_bf16 v[128:131], v[88:91], a[60:63], v[128:131]
    ds_read_b64_tr_b16 v[102:103], v23 offset:1024
    v_mfma_f32_16x16x32_bf16 v[148:151], v[92:95], a[60:63], v[148:151]
    ds_read_b64_tr_b16 v[104:105], v22 offset:2048
    ds_read_b64_tr_b16 v[106:107], v22 offset:3072
    v_mfma_f32_16x16x32_bf16 v[132:135], v[88:91], a[64:67], v[132:135]
    ds_read_b64_tr_b16 v[108:109], v23 offset:2048
    v_mfma_f32_16x16x32_bf16 v[152:155], v[92:95], a[64:67], v[152:155]
    ds_read_b64_tr_b16 v[110:111], v23 offset:3072
    v_mfma_f32_16x16x32_bf16 v[136:139], v[88:91], a[68:71], v[136:139]
    ds_read_b64_tr_b16 v[112:113], v22 offset:4096
    ds_read_b64_tr_b16 v[114:115], v22 offset:5120
    v_mfma_f32_16x16x32_bf16 v[156:159], v[92:95], a[68:71], v[156:159]
    ds_read_b64_tr_b16 v[116:117], v23 offset:4096
    v_mfma_f32_16x16x32_bf16 v[140:143], v[88:91], a[72:75], v[140:143]
    ds_read_b64_tr_b16 v[118:119], v23 offset:5120
    v_mfma_f32_16x16x32_bf16 v[160:163], v[92:95], a[72:75], v[160:163]
    ds_read_b64_tr_b16 v[120:121], v22 offset:6144
    v_mfma_f32_16x16x32_bf16 v[144:147], v[88:91], a[76:79], v[144:147]
    ds_read_b64_tr_b16 v[122:123], v22 offset:7168
    ds_read_b64_tr_b16 v[124:125], v23 offset:6144
    v_mfma_f32_16x16x32_bf16 v[164:167], v[92:95], a[76:79], v[164:167]
    ds_read_b64_tr_b16 v[126:127], v23 offset:7168
    s_waitcnt vmcnt(8)
    s_waitcnt lgkmcnt(0)
    v_mfma_f32_16x16x32_bf16 v[128:131], v[96:99], a[80:83], v[128:131]
    v_mfma_f32_16x16x32_bf16 v[148:151], v[100:103], a[80:83], v[148:151]
    s_add_u32 m0, s67, 0
    s_xor_b32 s29, s73, 4
    s_and_b32 s30, s29, 1
    s_lshl_b32 s30, s30, 17
    s_lshr_b32 s29, s29, 1
    s_lshl_b32 s29, s29, 6
    s_add_u32 s29, s29, s30
    buffer_load_dwordx4 v16, s[84:87], s29 offen offset:0 lds
    v_mfma_f32_16x16x32_bf16 v[132:135], v[96:99], a[84:87], v[132:135]
    v_mfma_f32_16x16x32_bf16 v[152:155], v[100:103], a[84:87], v[152:155]
    buffer_load_dwordx4 v17, s[84:87], s29 offen offset:1024 lds
    v_mfma_f32_16x16x32_bf16 v[136:139], v[96:99], a[88:91], v[136:139]
    v_mfma_f32_16x16x32_bf16 v[156:159], v[100:103], a[88:91], v[156:159]
    v_mfma_f32_16x16x32_bf16 v[140:143], v[96:99], a[92:95], v[140:143]
    buffer_load_dwordx4 v18, s[84:87], s29 offen offset:2048 lds
    v_mfma_f32_16x16x32_bf16 v[160:163], v[100:103], a[92:95], v[160:163]
    v_mfma_f32_16x16x32_bf16 v[144:147], v[96:99], a[96:99], v[144:147]
    buffer_load_dwordx4 v19, s[84:87], s29 offen offset:3072 lds
    v_mfma_f32_16x16x32_bf16 v[164:167], v[100:103], a[96:99], v[164:167]
    v_mfma_f32_16x16x32_bf16 v[128:131], v[104:107], a[100:103], v[128:131]
    v_mfma_f32_16x16x32_bf16 v[148:151], v[108:111], a[100:103], v[148:151]
    s_add_u32 m0, s67, 4096
    s_add_u32 s29, s29, 65536
    buffer_load_dwordx4 v16, s[84:87], s29 offen offset:0 lds
    v_mfma_f32_16x16x32_bf16 v[132:135], v[104:107], a[104:107], v[132:135]
    v_mfma_f32_16x16x32_bf16 v[152:155], v[108:111], a[104:107], v[152:155]
    buffer_load_dwordx4 v17, s[84:87], s29 offen offset:1024 lds
    v_mfma_f32_16x16x32_bf16 v[136:139], v[104:107], a[108:111], v[136:139]
    v_mfma_f32_16x16x32_bf16 v[156:159], v[108:111], a[108:111], v[156:159]
    v_mfma_f32_16x16x32_bf16 v[140:143], v[104:107], a[112:115], v[140:143]
    buffer_load_dwordx4 v18, s[84:87], s29 offen offset:2048 lds
    v_mfma_f32_16x16x32_bf16 v[160:163], v[108:111], a[112:115], v[160:163]
    v_mfma_f32_16x16x32_bf16 v[144:147], v[104:107], a[116:119], v[144:147]
    buffer_load_dwordx4 v19, s[84:87], s29 offen offset:3072 lds
    v_mfma_f32_16x16x32_bf16 v[164:167], v[108:111], a[116:119], v[164:167]
    v_mfma_f32_16x16x32_bf16 v[128:131], v[112:115], a[120:123], v[128:131]
    ds_read_b64_tr_b16 v[64:65], v22 offset:8192
    v_mfma_f32_16x16x32_bf16 v[148:151], v[116:119], a[120:123], v[148:151]
    ds_read_b64_tr_b16 v[66:67], v22 offset:9216
    v_mfma_f32_16x16x32_bf16 v[132:135], v[112:115], a[124:127], v[132:135]
    v_mfma_f32_16x16x32_bf16 v[152:155], v[116:119], a[124:127], v[152:155]
    ds_read_b64_tr_b16 v[68:69], v23 offset:8192
    v_mfma_f32_16x16x32_bf16 v[136:139], v[112:115], a[128:131], v[136:139]
    ds_read_b64_tr_b16 v[70:71], v23 offset:9216
    v_mfma_f32_16x16x32_bf16 v[156:159], v[116:119], a[128:131], v[156:159]
    ds_read_b64_tr_b16 v[72:73], v22 offset:10240
    v_mfma_f32_16x16x32_bf16 v[140:143], v[112:115], a[132:135], v[140:143]
    ds_read_b64_tr_b16 v[74:75], v22 offset:11264
    v_mfma_f32_16x16x32_bf16 v[160:163], v[116:119], a[132:135], v[160:163]
    v_mfma_f32_16x16x32_bf16 v[144:147], v[112:115], a[136:139], v[144:147]
    ds_read_b64_tr_b16 v[76:77], v23 offset:10240
    v_mfma_f32_16x16x32_bf16 v[164:167], v[116:119], a[136:139], v[164:167]
    ds_read_b64_tr_b16 v[78:79], v23 offset:11264
    v_mfma_f32_16x16x32_bf16 v[128:131], v[120:123], a[140:143], v[128:131]
    ds_read_b64_tr_b16 v[80:81], v22 offset:12288
    v_mfma_f32_16x16x32_bf16 v[148:151], v[124:127], a[140:143], v[148:151]
    ds_read_b64_tr_b16 v[82:83], v22 offset:13312
    v_mfma_f32_16x16x32_bf16 v[132:135], v[120:123], a[144:147], v[132:135]
    v_mfma_f32_16x16x32_bf16 v[152:155], v[124:127], a[144:147], v[152:155]
    ds_read_b64_tr_b16 v[84:85], v23 offset:12288
    v_mfma_f32_16x16x32_bf16 v[136:139], v[120:123], a[148:151], v[136:139]
    ds_read_b64_tr_b16 v[86:87], v23 offset:13312
    v_mfma_f32_16x16x32_bf16 v[156:159], v[124:127], a[148:151], v[156:159]
    ds_read_b64_tr_b16 v[88:89], v22 offset:14336
    v_mfma_f32_16x16x32_bf16 v[140:143], v[120:123], a[152:155], v[140:143]
    ds_read_b64_tr_b16 v[90:91], v22 offset:15360
    v_mfma_f32_16x16x32_bf16 v[160:163], v[124:127], a[152:155], v[160:163]
    v_mfma_f32_16x16x32_bf16 v[144:147], v[120:123], a[156:159], v[144:147]
    ds_read_b64_tr_b16 v[92:93], v23 offset:14336
    v_mfma_f32_16x16x32_bf16 v[164:167], v[124:127], a[156:159], v[164:167]
    ds_read_b64_tr_b16 v[94:95], v23 offset:15360
    s_waitcnt vmcnt(8)
    s_waitcnt lgkmcnt(0)
    v_mfma_f32_16x16x32_bf16 v[168:171], v[64:67], a[0:3], 0
    s_add_u32 m0, s67, 8192
    s_xor_b32 s29, s73, 5
    s_and_b32 s30, s29, 1
    s_lshl_b32 s30, s30, 17
    s_lshr_b32 s29, s29, 1
    s_lshl_b32 s29, s29, 6
    s_add_u32 s29, s29, s30
    buffer_load_dwordx4 v16, s[84:87], s29 offen offset:0 lds
    v_mfma_f32_16x16x32_bf16 v[188:191], v[68:71], a[0:3], 0
    buffer_load_dwordx4 v17, s[84:87], s29 offen offset:1024 lds
    v_mfma_f32_16x16x32_bf16 v[172:175], v[64:67], a[4:7], 0
    v_mfma_f32_16x16x32_bf16 v[192:195], v[68:71], a[4:7], 0
    buffer_load_dwordx4 v18, s[84:87], s29 offen offset:2048 lds
    v_mfma_f32_16x16x32_bf16 v[176:179], v[64:67], a[8:11], 0
    buffer_load_dwordx4 v19, s[84:87], s29 offen offset:3072 lds
    v_mfma_f32_16x16x32_bf16 v[196:199], v[68:71], a[8:11], 0
    s_add_u32 m0, s67, 12288
    s_add_u32 s29, s29, 65536
    buffer_load_dwordx4 v16, s[84:87], s29 offen offset:0 lds
    v_mfma_f32_16x16x32_bf16 v[180:183], v[64:67], a[12:15], 0
    v_mfma_f32_16x16x32_bf16 v[200:203], v[68:71], a[12:15], 0
    buffer_load_dwordx4 v17, s[84:87], s29 offen offset:1024 lds
    v_mfma_f32_16x16x32_bf16 v[184:187], v[64:67], a[16:19], 0
    buffer_load_dwordx4 v18, s[84:87], s29 offen offset:2048 lds
    v_mfma_f32_16x16x32_bf16 v[204:207], v[68:71], a[16:19], 0
    buffer_load_dwordx4 v19, s[84:87], s29 offen offset:3072 lds
    v_mfma_f32_16x16x32_bf16 v[168:171], v[72:75], a[20:23], v[168:171]
    ds_read_b64_tr_b16 v[96:97], v20 offset:0
    v_mfma_f32_16x16x32_bf16 v[188:191], v[76:79], a[20:23], v[188:191]
    ds_read_b64_tr_b16 v[98:99], v20 offset:1024
    ds_read_b64_tr_b16 v[100:101], v21 offset:0
    v_mfma_f32_16x16x32_bf16 v[172:175], v[72:75], a[24:27], v[172:175]
    ds_read_b64_tr_b16 v[102:103], v21 offset:1024
    v_mfma_f32_16x16x32_bf16 v[192:195], v[76:79], a[24:27], v[192:195]
    ds_read_b64_tr_b16 v[104:105], v20 offset:2048
    ds_read_b64_tr_b16 v[106:107], v20 offset:3072
    v_mfma_f32_16x16x32_bf16 v[176:179], v[72:75], a[28:31], v[176:179]
    ds_read_b64_tr_b16 v[108:109], v21 offset:2048
    v_mfma_f32_16x16x32_bf16 v[196:199], v[76:79], a[28:31], v[196:199]
    ds_read_b64_tr_b16 v[110:111], v21 offset:3072
    ds_read_b64_tr_b16 v[112:113], v20 offset:4096
    v_mfma_f32_16x16x32_bf16 v[180:183], v[72:75], a[32:35], v[180:183]
    ds_read_b64_tr_b16 v[114:115], v20 offset:5120
    v_mfma_f32_16x16x32_bf16 v[200:203], v[76:79], a[32:35], v[200:203]
    ds_read_b64_tr_b16 v[116:117], v21 offset:4096
    ds_read_b64_tr_b16 v[118:119], v21 offset:5120
    v_mfma_f32_16x16x32_bf16 v[184:187], v[72:75], a[36:39], v[184:187]
    ds_read_b64_tr_b16 v[120:121], v20 offset:6144
    v_mfma_f32_16x16x32_bf16 v[204:207], v[76:79], a[36:39], v[204:207]
    ds_read_b64_tr_b16 v[122:123], v20 offset:7168
    ds_read_b64_tr_b16 v[124:125], v21 offset:6144
    v_mfma_f32_16x16x32_bf16 v[168:171], v[80:83], a[40:43], v[168:171]
    ds_read_b64_tr_b16 v[126:127], v21 offset:7168
    v_mfma_f32_16x16x32_bf16 v[188:191], v[84:87], a[40:43], v[188:191]
    v_cvt_pk_bf16_f32 v208, v128, v129
    v_cvt_pk_bf16_f32 v209, v130, v131
    v_cvt_pk_bf16_f32 v210, v148, v149
    v_cvt_pk_bf16_f32 v211, v150, v151
    v_mfma_f32_16x16x32_bf16 v[172:175], v[80:83], a[44:47], v[172:175]
    v_mfma_f32_16x16x32_bf16 v[192:195], v[84:87], a[44:47], v[192:195]
    s_lshr_b32 s31, s73, 1
    s_xor_b32 s31, s31, 0
    s_mul_i32 s31, s31, 81920
    s_add_u32 s31, s31, s71
    buffer_store_dwordx4 v[208:211], v33, s[92:95], s31 offen offset:0 sc0 sc1
    v_mfma_f32_16x16x32_bf16 v[176:179], v[80:83], a[48:51], v[176:179]
    v_mfma_f32_16x16x32_bf16 v[196:199], v[84:87], a[48:51], v[196:199]
    v_cvt_pk_bf16_f32 v212, v132, v133
    v_cvt_pk_bf16_f32 v213, v134, v135
    v_cvt_pk_bf16_f32 v214, v152, v153
    v_cvt_pk_bf16_f32 v215, v154, v155
    v_mfma_f32_16x16x32_bf16 v[180:183], v[80:83], a[52:55], v[180:183]
    v_mfma_f32_16x16x32_bf16 v[200:203], v[84:87], a[52:55], v[200:203]
    buffer_store_dwordx4 v[212:215], v33, s[92:95], s31 offen offset:1024 sc0 sc1
    v_mfma_f32_16x16x32_bf16 v[184:187], v[80:83], a[56:59], v[184:187]
    v_mfma_f32_16x16x32_bf16 v[204:207], v[84:87], a[56:59], v[204:207]
    v_cvt_pk_bf16_f32 v216, v136, v137
    v_cvt_pk_bf16_f32 v217, v138, v139
    v_cvt_pk_bf16_f32 v218, v156, v157
    v_cvt_pk_bf16_f32 v219, v158, v159
    v_mfma_f32_16x16x32_bf16 v[168:171], v[88:91], a[60:63], v[168:171]
    v_mfma_f32_16x16x32_bf16 v[188:191], v[92:95], a[60:63], v[188:191]
    buffer_store_dwordx4 v[216:219], v33, s[92:95], s31 offen offset:2048 sc0 sc1
    v_mfma_f32_16x16x32_bf16 v[172:175], v[88:91], a[64:67], v[172:175]
    v_mfma_f32_16x16x32_bf16 v[192:195], v[92:95], a[64:67], v[192:195]
    v_cvt_pk_bf16_f32 v220, v140, v141
    v_cvt_pk_bf16_f32 v221, v142, v143
    v_cvt_pk_bf16_f32 v222, v160, v161
    v_cvt_pk_bf16_f32 v223, v162, v163
    v_mfma_f32_16x16x32_bf16 v[176:179], v[88:91], a[68:71], v[176:179]
    v_mfma_f32_16x16x32_bf16 v[196:199], v[92:95], a[68:71], v[196:199]
    buffer_store_dwordx4 v[220:223], v33, s[92:95], s31 offen offset:3072 sc0 sc1
    v_mfma_f32_16x16x32_bf16 v[180:183], v[88:91], a[72:75], v[180:183]
    v_mfma_f32_16x16x32_bf16 v[200:203], v[92:95], a[72:75], v[200:203]
    v_cvt_pk_bf16_f32 v224, v144, v145
    v_cvt_pk_bf16_f32 v225, v146, v147
    v_cvt_pk_bf16_f32 v226, v164, v165
    v_cvt_pk_bf16_f32 v227, v166, v167
    v_mfma_f32_16x16x32_bf16 v[184:187], v[88:91], a[76:79], v[184:187]
    v_mfma_f32_16x16x32_bf16 v[204:207], v[92:95], a[76:79], v[204:207]
    s_add_u32 s31, s31, 4096
    buffer_store_dwordx4 v[224:227], v33, s[92:95], s31 offen offset:0 sc0 sc1
    s_waitcnt vmcnt(13)
    s_waitcnt lgkmcnt(0)
    v_mfma_f32_16x16x32_bf16 v[168:171], v[96:99], a[80:83], v[168:171]
    v_mfma_f32_16x16x32_bf16 v[188:191], v[100:103], a[80:83], v[188:191]
    s_add_u32 m0, s74, 0
    s_xor_b32 s29, s73, 6
    s_and_b32 s30, s29, 1
    s_lshl_b32 s30, s30, 17
    s_lshr_b32 s29, s29, 1
    s_lshl_b32 s29, s29, 6
    s_add_u32 s29, s29, s30
    buffer_load_dwordx4 v16, s[84:87], s29 offen offset:0 lds
    v_mfma_f32_16x16x32_bf16 v[172:175], v[96:99], a[84:87], v[172:175]
    v_mfma_f32_16x16x32_bf16 v[192:195], v[100:103], a[84:87], v[192:195]
    buffer_load_dwordx4 v17, s[84:87], s29 offen offset:1024 lds
    v_mfma_f32_16x16x32_bf16 v[176:179], v[96:99], a[88:91], v[176:179]
    v_mfma_f32_16x16x32_bf16 v[196:199], v[100:103], a[88:91], v[196:199]
    v_mfma_f32_16x16x32_bf16 v[180:183], v[96:99], a[92:95], v[180:183]
    buffer_load_dwordx4 v18, s[84:87], s29 offen offset:2048 lds
    v_mfma_f32_16x16x32_bf16 v[200:203], v[100:103], a[92:95], v[200:203]
    v_mfma_f32_16x16x32_bf16 v[184:187], v[96:99], a[96:99], v[184:187]
    buffer_load_dwordx4 v19, s[84:87], s29 offen offset:3072 lds
    v_mfma_f32_16x16x32_bf16 v[204:207], v[100:103], a[96:99], v[204:207]
    v_mfma_f32_16x16x32_bf16 v[168:171], v[104:107], a[100:103], v[168:171]
    v_mfma_f32_16x16x32_bf16 v[188:191], v[108:111], a[100:103], v[188:191]
    s_add_u32 m0, s74, 4096
    s_add_u32 s29, s29, 65536
    buffer_load_dwordx4 v16, s[84:87], s29 offen offset:0 lds
    v_mfma_f32_16x16x32_bf16 v[172:175], v[104:107], a[104:107], v[172:175]
    v_mfma_f32_16x16x32_bf16 v[192:195], v[108:111], a[104:107], v[192:195]
    buffer_load_dwordx4 v17, s[84:87], s29 offen offset:1024 lds
    v_mfma_f32_16x16x32_bf16 v[176:179], v[104:107], a[108:111], v[176:179]
    v_mfma_f32_16x16x32_bf16 v[196:199], v[108:111], a[108:111], v[196:199]
    v_mfma_f32_16x16x32_bf16 v[180:183], v[104:107], a[112:115], v[180:183]
    buffer_load_dwordx4 v18, s[84:87], s29 offen offset:2048 lds
    v_mfma_f32_16x16x32_bf16 v[200:203], v[108:111], a[112:115], v[200:203]
    v_mfma_f32_16x16x32_bf16 v[184:187], v[104:107], a[116:119], v[184:187]
    buffer_load_dwordx4 v19, s[84:87], s29 offen offset:3072 lds
    v_mfma_f32_16x16x32_bf16 v[204:207], v[108:111], a[116:119], v[204:207]
    v_mfma_f32_16x16x32_bf16 v[168:171], v[112:115], a[120:123], v[168:171]
    ds_read_b64_tr_b16 v[64:65], v22 offset:0
    v_mfma_f32_16x16x32_bf16 v[188:191], v[116:119], a[120:123], v[188:191]
    ds_read_b64_tr_b16 v[66:67], v22 offset:1024
    v_mfma_f32_16x16x32_bf16 v[172:175], v[112:115], a[124:127], v[172:175]
    v_mfma_f32_16x16x32_bf16 v[192:195], v[116:119], a[124:127], v[192:195]
    ds_read_b64_tr_b16 v[68:69], v23 offset:0
    v_mfma_f32_16x16x32_bf16 v[176:179], v[112:115], a[128:131], v[176:179]
    ds_read_b64_tr_b16 v[70:71], v23 offset:1024
    v_mfma_f32_16x16x32_bf16 v[196:199], v[116:119], a[128:131], v[196:199]
    ds_read_b64_tr_b16 v[72:73], v22 offset:2048
    v_mfma_f32_16x16x32_bf16 v[180:183], v[112:115], a[132:135], v[180:183]
    ds_read_b64_tr_b16 v[74:75], v22 offset:3072
    v_mfma_f32_16x16x32_bf16 v[200:203], v[116:119], a[132:135], v[200:203]
    v_mfma_f32_16x16x32_bf16 v[184:187], v[112:115], a[136:139], v[184:187]
    ds_read_b64_tr_b16 v[76:77], v23 offset:2048
    v_mfma_f32_16x16x32_bf16 v[204:207], v[116:119], a[136:139], v[204:207]
    ds_read_b64_tr_b16 v[78:79], v23 offset:3072
    v_mfma_f32_16x16x32_bf16 v[168:171], v[120:123], a[140:143], v[168:171]
    ds_read_b64_tr_b16 v[80:81], v22 offset:4096
    v_mfma_f32_16x16x32_bf16 v[188:191], v[124:127], a[140:143], v[188:191]
    ds_read_b64_tr_b16 v[82:83], v22 offset:5120
    v_mfma_f32_16x16x32_bf16 v[172:175], v[120:123], a[144:147], v[172:175]
    v_mfma_f32_16x16x32_bf16 v[192:195], v[124:127], a[144:147], v[192:195]
    ds_read_b64_tr_b16 v[84:85], v23 offset:4096
    v_mfma_f32_16x16x32_bf16 v[176:179], v[120:123], a[148:151], v[176:179]
    ds_read_b64_tr_b16 v[86:87], v23 offset:5120
    v_mfma_f32_16x16x32_bf16 v[196:199], v[124:127], a[148:151], v[196:199]
    ds_read_b64_tr_b16 v[88:89], v22 offset:6144
    v_mfma_f32_16x16x32_bf16 v[180:183], v[120:123], a[152:155], v[180:183]
    ds_read_b64_tr_b16 v[90:91], v22 offset:7168
    v_mfma_f32_16x16x32_bf16 v[200:203], v[124:127], a[152:155], v[200:203]
    v_mfma_f32_16x16x32_bf16 v[184:187], v[120:123], a[156:159], v[184:187]
    ds_read_b64_tr_b16 v[92:93], v23 offset:6144
    v_mfma_f32_16x16x32_bf16 v[204:207], v[124:127], a[156:159], v[204:207]
    ds_read_b64_tr_b16 v[94:95], v23 offset:7168
    s_waitcnt vmcnt(13)
    s_waitcnt lgkmcnt(0)
    v_mfma_f32_16x16x32_bf16 v[128:131], v[64:67], a[0:3], 0
    s_add_u32 m0, s67, 0
    s_xor_b32 s29, s73, 7
    s_and_b32 s30, s29, 1
    s_lshl_b32 s30, s30, 17
    s_lshr_b32 s29, s29, 1
    s_lshl_b32 s29, s29, 6
    s_add_u32 s29, s29, s30
    buffer_load_dwordx4 v16, s[84:87], s29 offen offset:0 lds
    v_mfma_f32_16x16x32_bf16 v[148:151], v[68:71], a[0:3], 0
    buffer_load_dwordx4 v17, s[84:87], s29 offen offset:1024 lds
    v_mfma_f32_16x16x32_bf16 v[132:135], v[64:67], a[4:7], 0
    v_mfma_f32_16x16x32_bf16 v[152:155], v[68:71], a[4:7], 0
    buffer_load_dwordx4 v18, s[84:87], s29 offen offset:2048 lds
    v_mfma_f32_16x16x32_bf16 v[136:139], v[64:67], a[8:11], 0
    buffer_load_dwordx4 v19, s[84:87], s29 offen offset:3072 lds
    v_mfma_f32_16x16x32_bf16 v[156:159], v[68:71], a[8:11], 0
    s_add_u32 m0, s67, 4096
    s_add_u32 s29, s29, 65536
    buffer_load_dwordx4 v16, s[84:87], s29 offen offset:0 lds
    v_mfma_f32_16x16x32_bf16 v[140:143], v[64:67], a[12:15], 0
    v_mfma_f32_16x16x32_bf16 v[160:163], v[68:71], a[12:15], 0
    buffer_load_dwordx4 v17, s[84:87], s29 offen offset:1024 lds
    v_mfma_f32_16x16x32_bf16 v[144:147], v[64:67], a[16:19], 0
    buffer_load_dwordx4 v18, s[84:87], s29 offen offset:2048 lds
    v_mfma_f32_16x16x32_bf16 v[164:167], v[68:71], a[16:19], 0
    buffer_load_dwordx4 v19, s[84:87], s29 offen offset:3072 lds
    v_mfma_f32_16x16x32_bf16 v[128:131], v[72:75], a[20:23], v[128:131]
    ds_read_b64_tr_b16 v[96:97], v22 offset:8192
    v_mfma_f32_16x16x32_bf16 v[148:151], v[76:79], a[20:23], v[148:151]
    ds_read_b64_tr_b16 v[98:99], v22 offset:9216
    ds_read_b64_tr_b16 v[100:101], v23 offset:8192
    v_mfma_f32_16x16x32_bf16 v[132:135], v[72:75], a[24:27], v[132:135]
    ds_read_b64_tr_b16 v[102:103], v23 offset:9216
    v_mfma_f32_16x16x32_bf16 v[152:155], v[76:79], a[24:27], v[152:155]
    ds_read_b64_tr_b16 v[104:105], v22 offset:10240
    ds_read_b64_tr_b16 v[106:107], v22 offset:11264
    v_mfma_f32_16x16x32_bf16 v[136:139], v[72:75], a[28:31], v[136:139]
    ds_read_b64_tr_b16 v[108:109], v23 offset:10240
    v_mfma_f32_16x16x32_bf16 v[156:159], v[76:79], a[28:31], v[156:159]
    ds_read_b64_tr_b16 v[110:111], v23 offset:11264
    ds_read_b64_tr_b16 v[112:113], v22 offset:12288
    v_mfma_f32_16x16x32_bf16 v[140:143], v[72:75], a[32:35], v[140:143]
    ds_read_b64_tr_b16 v[114:115], v22 offset:13312
    v_mfma_f32_16x16x32_bf16 v[160:163], v[76:79], a[32:35], v[160:163]
    ds_read_b64_tr_b16 v[116:117], v23 offset:12288
    ds_read_b64_tr_b16 v[118:119], v23 offset:13312
    v_mfma_f32_16x16x32_bf16 v[144:147], v[72:75], a[36:39], v[144:147]
    ds_read_b64_tr_b16 v[120:121], v22 offset:14336
    v_mfma_f32_16x16x32_bf16 v[164:167], v[76:79], a[36:39], v[164:167]
    ds_read_b64_tr_b16 v[122:123], v22 offset:15360
    ds_read_b64_tr_b16 v[124:125], v23 offset:14336
    v_mfma_f32_16x16x32_bf16 v[128:131], v[80:83], a[40:43], v[128:131]
    ds_read_b64_tr_b16 v[126:127], v23 offset:15360
    v_mfma_f32_16x16x32_bf16 v[148:151], v[84:87], a[40:43], v[148:151]
    v_cvt_pk_bf16_f32 v208, v168, v169
    v_cvt_pk_bf16_f32 v209, v170, v171
    v_cvt_pk_bf16_f32 v210, v188, v189
    v_cvt_pk_bf16_f32 v211, v190, v191
    v_mfma_f32_16x16x32_bf16 v[132:135], v[80:83], a[44:47], v[132:135]
    v_mfma_f32_16x16x32_bf16 v[152:155], v[84:87], a[44:47], v[152:155]
    s_lshr_b32 s31, s73, 1
    s_xor_b32 s31, s31, 1
    s_mul_i32 s31, s31, 81920
    s_add_u32 s31, s31, s71
    buffer_store_dwordx4 v[208:211], v33, s[92:95], s31 offen offset:0 sc0 sc1
    v_mfma_f32_16x16x32_bf16 v[136:139], v[80:83], a[48:51], v[136:139]
    v_mfma_f32_16x16x32_bf16 v[156:159], v[84:87], a[48:51], v[156:159]
    v_cvt_pk_bf16_f32 v212, v172, v173
    v_cvt_pk_bf16_f32 v213, v174, v175
    v_cvt_pk_bf16_f32 v214, v192, v193
    v_cvt_pk_bf16_f32 v215, v194, v195
    v_mfma_f32_16x16x32_bf16 v[140:143], v[80:83], a[52:55], v[140:143]
    v_mfma_f32_16x16x32_bf16 v[160:163], v[84:87], a[52:55], v[160:163]
    buffer_store_dwordx4 v[212:215], v33, s[92:95], s31 offen offset:1024 sc0 sc1
    v_mfma_f32_16x16x32_bf16 v[144:147], v[80:83], a[56:59], v[144:147]
    v_mfma_f32_16x16x32_bf16 v[164:167], v[84:87], a[56:59], v[164:167]
    v_cvt_pk_bf16_f32 v216, v176, v177
    v_cvt_pk_bf16_f32 v217, v178, v179
    v_cvt_pk_bf16_f32 v218, v196, v197
    v_cvt_pk_bf16_f32 v219, v198, v199
    v_mfma_f32_16x16x32_bf16 v[128:131], v[88:91], a[60:63], v[128:131]
    v_mfma_f32_16x16x32_bf16 v[148:151], v[92:95], a[60:63], v[148:151]
    buffer_store_dwordx4 v[216:219], v33, s[92:95], s31 offen offset:2048 sc0 sc1
    v_mfma_f32_16x16x32_bf16 v[132:135], v[88:91], a[64:67], v[132:135]
    v_mfma_f32_16x16x32_bf16 v[152:155], v[92:95], a[64:67], v[152:155]
    v_cvt_pk_bf16_f32 v220, v180, v181
    v_cvt_pk_bf16_f32 v221, v182, v183
    v_cvt_pk_bf16_f32 v222, v200, v201
    v_cvt_pk_bf16_f32 v223, v202, v203
    v_mfma_f32_16x16x32_bf16 v[136:139], v[88:91], a[68:71], v[136:139]
    v_mfma_f32_16x16x32_bf16 v[156:159], v[92:95], a[68:71], v[156:159]
    buffer_store_dwordx4 v[220:223], v33, s[92:95], s31 offen offset:3072 sc0 sc1
    v_mfma_f32_16x16x32_bf16 v[140:143], v[88:91], a[72:75], v[140:143]
    v_mfma_f32_16x16x32_bf16 v[160:163], v[92:95], a[72:75], v[160:163]
    v_cvt_pk_bf16_f32 v224, v184, v185
    v_cvt_pk_bf16_f32 v225, v186, v187
    v_cvt_pk_bf16_f32 v226, v204, v205
    v_cvt_pk_bf16_f32 v227, v206, v207
    v_mfma_f32_16x16x32_bf16 v[144:147], v[88:91], a[76:79], v[144:147]
    v_mfma_f32_16x16x32_bf16 v[164:167], v[92:95], a[76:79], v[164:167]
    s_add_u32 s31, s31, 4096
    buffer_store_dwordx4 v[224:227], v33, s[92:95], s31 offen offset:0 sc0 sc1
    s_waitcnt vmcnt(13)
    s_waitcnt lgkmcnt(0)
    v_mfma_f32_16x16x32_bf16 v[128:131], v[96:99], a[80:83], v[128:131]
    v_mfma_f32_16x16x32_bf16 v[148:151], v[100:103], a[80:83], v[148:151]
    ds_read_b64_tr_b16 v[64:65], v20 offset:0
    v_mfma_f32_16x16x32_bf16 v[132:135], v[96:99], a[84:87], v[132:135]
    v_mfma_f32_16x16x32_bf16 v[152:155], v[100:103], a[84:87], v[152:155]
    ds_read_b64_tr_b16 v[66:67], v20 offset:1024
    v_mfma_f32_16x16x32_bf16 v[136:139], v[96:99], a[88:91], v[136:139]
    v_mfma_f32_16x16x32_bf16 v[156:159], v[100:103], a[88:91], v[156:159]
    v_mfma_f32_16x16x32_bf16 v[140:143], v[96:99], a[92:95], v[140:143]
    ds_read_b64_tr_b16 v[68:69], v21 offset:0
    v_mfma_f32_16x16x32_bf16 v[160:163], v[100:103], a[92:95], v[160:163]
    v_mfma_f32_16x16x32_bf16 v[144:147], v[96:99], a[96:99], v[144:147]
    ds_read_b64_tr_b16 v[70:71], v21 offset:1024
    v_mfma_f32_16x16x32_bf16 v[164:167], v[100:103], a[96:99], v[164:167]
    v_mfma_f32_16x16x32_bf16 v[128:131], v[104:107], a[100:103], v[128:131]
    v_mfma_f32_16x16x32_bf16 v[148:151], v[108:111], a[100:103], v[148:151]
    ds_read_b64_tr_b16 v[72:73], v20 offset:2048
    v_mfma_f32_16x16x32_bf16 v[132:135], v[104:107], a[104:107], v[132:135]
    v_mfma_f32_16x16x32_bf16 v[152:155], v[108:111], a[104:107], v[152:155]
    ds_read_b64_tr_b16 v[74:75], v20 offset:3072
    v_mfma_f32_16x16x32_bf16 v[136:139], v[104:107], a[108:111], v[136:139]
    v_mfma_f32_16x16x32_bf16 v[156:159], v[108:111], a[108:111], v[156:159]
    v_mfma_f32_16x16x32_bf16 v[140:143], v[104:107], a[112:115], v[140:143]
    ds_read_b64_tr_b16 v[76:77], v21 offset:2048
    v_mfma_f32_16x16x32_bf16 v[160:163], v[108:111], a[112:115], v[160:163]
    v_mfma_f32_16x16x32_bf16 v[144:147], v[104:107], a[116:119], v[144:147]
    ds_read_b64_tr_b16 v[78:79], v21 offset:3072
    v_mfma_f32_16x16x32_bf16 v[164:167], v[108:111], a[116:119], v[164:167]
    v_mfma_f32_16x16x32_bf16 v[128:131], v[112:115], a[120:123], v[128:131]
    v_mfma_f32_16x16x32_bf16 v[148:151], v[116:119], a[120:123], v[148:151]
    ds_read_b64_tr_b16 v[80:81], v20 offset:4096
    v_mfma_f32_16x16x32_bf16 v[132:135], v[112:115], a[124:127], v[132:135]
    v_mfma_f32_16x16x32_bf16 v[152:155], v[116:119], a[124:127], v[152:155]
    ds_read_b64_tr_b16 v[82:83], v20 offset:5120
    v_mfma_f32_16x16x32_bf16 v[136:139], v[112:115], a[128:131], v[136:139]
    v_mfma_f32_16x16x32_bf16 v[156:159], v[116:119], a[128:131], v[156:159]
    v_mfma_f32_16x16x32_bf16 v[140:143], v[112:115], a[132:135], v[140:143]
    ds_read_b64_tr_b16 v[84:85], v21 offset:4096
    v_mfma_f32_16x16x32_bf16 v[160:163], v[116:119], a[132:135], v[160:163]
    v_mfma_f32_16x16x32_bf16 v[144:147], v[112:115], a[136:139], v[144:147]
    ds_read_b64_tr_b16 v[86:87], v21 offset:5120
    v_mfma_f32_16x16x32_bf16 v[164:167], v[116:119], a[136:139], v[164:167]
    v_mfma_f32_16x16x32_bf16 v[128:131], v[120:123], a[140:143], v[128:131]
    v_mfma_f32_16x16x32_bf16 v[148:151], v[124:127], a[140:143], v[148:151]
    ds_read_b64_tr_b16 v[88:89], v20 offset:6144
    v_mfma_f32_16x16x32_bf16 v[132:135], v[120:123], a[144:147], v[132:135]
    v_mfma_f32_16x16x32_bf16 v[152:155], v[124:127], a[144:147], v[152:155]
    ds_read_b64_tr_b16 v[90:91], v20 offset:7168
    v_mfma_f32_16x16x32_bf16 v[136:139], v[120:123], a[148:151], v[136:139]
    v_mfma_f32_16x16x32_bf16 v[156:159], v[124:127], a[148:151], v[156:159]
    v_mfma_f32_16x16x32_bf16 v[140:143], v[120:123], a[152:155], v[140:143]
    ds_read_b64_tr_b16 v[92:93], v21 offset:6144
    v_mfma_f32_16x16x32_bf16 v[160:163], v[124:127], a[152:155], v[160:163]
    v_mfma_f32_16x16x32_bf16 v[144:147], v[120:123], a[156:159], v[144:147]
    ds_read_b64_tr_b16 v[94:95], v21 offset:7168
    v_mfma_f32_16x16x32_bf16 v[164:167], v[124:127], a[156:159], v[164:167]
    s_waitcnt vmcnt(5)
    s_waitcnt lgkmcnt(0)
    v_mfma_f32_16x16x32_bf16 v[168:171], v[64:67], a[0:3], 0
    ds_read_b64_tr_b16 v[96:97], v22 offset:0
    v_mfma_f32_16x16x32_bf16 v[188:191], v[68:71], a[0:3], 0
    ds_read_b64_tr_b16 v[98:99], v22 offset:1024
    v_mfma_f32_16x16x32_bf16 v[172:175], v[64:67], a[4:7], 0
    ds_read_b64_tr_b16 v[100:101], v23 offset:0
    v_mfma_f32_16x16x32_bf16 v[192:195], v[68:71], a[4:7], 0
    ds_read_b64_tr_b16 v[102:103], v23 offset:1024
    ds_read_b64_tr_b16 v[104:105], v22 offset:2048
    v_mfma_f32_16x16x32_bf16 v[176:179], v[64:67], a[8:11], 0
    ds_read_b64_tr_b16 v[106:107], v22 offset:3072
    v_mfma_f32_16x16x32_bf16 v[196:199], v[68:71], a[8:11], 0
    ds_read_b64_tr_b16 v[108:109], v23 offset:2048
    v_mfma_f32_16x16x32_bf16 v[180:183], v[64:67], a[12:15], 0
    ds_read_b64_tr_b16 v[110:111], v23 offset:3072
    v_mfma_f32_16x16x32_bf16 v[200:203], v[68:71], a[12:15], 0
    ds_read_b64_tr_b16 v[112:113], v22 offset:4096
    v_mfma_f32_16x16x32_bf16 v[184:187], v[64:67], a[16:19], 0
    ds_read_b64_tr_b16 v[114:115], v22 offset:5120
    v_mfma_f32_16x16x32_bf16 v[204:207], v[68:71], a[16:19], 0
    ds_read_b64_tr_b16 v[116:117], v23 offset:4096
    ds_read_b64_tr_b16 v[118:119], v23 offset:5120
    v_mfma_f32_16x16x32_bf16 v[168:171], v[72:75], a[20:23], v[168:171]
    ds_read_b64_tr_b16 v[120:121], v22 offset:6144
    v_mfma_f32_16x16x32_bf16 v[188:191], v[76:79], a[20:23], v[188:191]
    ds_read_b64_tr_b16 v[122:123], v22 offset:7168
    v_mfma_f32_16x16x32_bf16 v[172:175], v[72:75], a[24:27], v[172:175]
    ds_read_b64_tr_b16 v[124:125], v23 offset:6144
    v_mfma_f32_16x16x32_bf16 v[192:195], v[76:79], a[24:27], v[192:195]
    ds_read_b64_tr_b16 v[126:127], v23 offset:7168
    v_mfma_f32_16x16x32_bf16 v[176:179], v[72:75], a[28:31], v[176:179]
    v_mfma_f32_16x16x32_bf16 v[196:199], v[76:79], a[28:31], v[196:199]
    v_cvt_pk_bf16_f32 v208, v128, v129
    v_cvt_pk_bf16_f32 v209, v130, v131
    v_cvt_pk_bf16_f32 v210, v148, v149
    v_cvt_pk_bf16_f32 v211, v150, v151
    v_mfma_f32_16x16x32_bf16 v[180:183], v[72:75], a[32:35], v[180:183]
    v_mfma_f32_16x16x32_bf16 v[200:203], v[76:79], a[32:35], v[200:203]
    v_mfma_f32_16x16x32_bf16 v[184:187], v[72:75], a[36:39], v[184:187]
    s_lshr_b32 s31, s73, 1
    s_xor_b32 s31, s31, 2
    s_mul_i32 s31, s31, 81920
    s_add_u32 s31, s31, s71
    buffer_store_dwordx4 v[208:211], v33, s[92:95], s31 offen offset:0 sc0 sc1
    v_mfma_f32_16x16x32_bf16 v[204:207], v[76:79], a[36:39], v[204:207]
    v_mfma_f32_16x16x32_bf16 v[168:171], v[80:83], a[40:43], v[168:171]
    v_cvt_pk_bf16_f32 v212, v132, v133
    v_cvt_pk_bf16_f32 v213, v134, v135
    v_cvt_pk_bf16_f32 v214, v152, v153
    v_cvt_pk_bf16_f32 v215, v154, v155
    v_mfma_f32_16x16x32_bf16 v[188:191], v[84:87], a[40:43], v[188:191]
    v_mfma_f32_16x16x32_bf16 v[172:175], v[80:83], a[44:47], v[172:175]
    v_mfma_f32_16x16x32_bf16 v[192:195], v[84:87], a[44:47], v[192:195]
    buffer_store_dwordx4 v[212:215], v33, s[92:95], s31 offen offset:1024 sc0 sc1
    v_mfma_f32_16x16x32_bf16 v[176:179], v[80:83], a[48:51], v[176:179]
    v_mfma_f32_16x16x32_bf16 v[196:199], v[84:87], a[48:51], v[196:199]
    v_mfma_f32_16x16x32_bf16 v[180:183], v[80:83], a[52:55], v[180:183]
    v_cvt_pk_bf16_f32 v216, v136, v137
    v_cvt_pk_bf16_f32 v217, v138, v139
    v_cvt_pk_bf16_f32 v218, v156, v157
    v_cvt_pk_bf16_f32 v219, v158, v159
    v_mfma_f32_16x16x32_bf16 v[200:203], v[84:87], a[52:55], v[200:203]
    v_mfma_f32_16x16x32_bf16 v[184:187], v[80:83], a[56:59], v[184:187]
    buffer_store_dwordx4 v[216:219], v33, s[92:95], s31 offen offset:2048 sc0 sc1
    v_mfma_f32_16x16x32_bf16 v[204:207], v[84:87], a[56:59], v[204:207]
    v_mfma_f32_16x16x32_bf16 v[168:171], v[88:91], a[60:63], v[168:171]
    v_mfma_f32_16x16x32_bf16 v[188:191], v[92:95], a[60:63], v[188:191]
    v_cvt_pk_bf16_f32 v220, v140, v141
    v_cvt_pk_bf16_f32 v221, v142, v143
    v_cvt_pk_bf16_f32 v222, v160, v161
    v_cvt_pk_bf16_f32 v223, v162, v163
    v_mfma_f32_16x16x32_bf16 v[172:175], v[88:91], a[64:67], v[172:175]
    v_mfma_f32_16x16x32_bf16 v[192:195], v[92:95], a[64:67], v[192:195]
    buffer_store_dwordx4 v[220:223], v33, s[92:95], s31 offen offset:3072 sc0 sc1
    v_mfma_f32_16x16x32_bf16 v[176:179], v[88:91], a[68:71], v[176:179]
    v_mfma_f32_16x16x32_bf16 v[196:199], v[92:95], a[68:71], v[196:199]
    v_mfma_f32_16x16x32_bf16 v[180:183], v[88:91], a[72:75], v[180:183]
    v_cvt_pk_bf16_f32 v224, v144, v145
    v_cvt_pk_bf16_f32 v225, v146, v147
    v_cvt_pk_bf16_f32 v226, v164, v165
    v_cvt_pk_bf16_f32 v227, v166, v167
    v_mfma_f32_16x16x32_bf16 v[200:203], v[92:95], a[72:75], v[200:203]
    v_mfma_f32_16x16x32_bf16 v[184:187], v[88:91], a[76:79], v[184:187]
    v_mfma_f32_16x16x32_bf16 v[204:207], v[92:95], a[76:79], v[204:207]
    s_add_u32 s31, s31, 4096
    buffer_store_dwordx4 v[224:227], v33, s[92:95], s31 offen offset:0 sc0 sc1
    s_waitcnt lgkmcnt(0)
    v_mfma_f32_16x16x32_bf16 v[168:171], v[96:99], a[80:83], v[168:171]
    v_mfma_f32_16x16x32_bf16 v[188:191], v[100:103], a[80:83], v[188:191]
    v_mfma_f32_16x16x32_bf16 v[172:175], v[96:99], a[84:87], v[172:175]
    v_mfma_f32_16x16x32_bf16 v[192:195], v[100:103], a[84:87], v[192:195]
    v_mfma_f32_16x16x32_bf16 v[176:179], v[96:99], a[88:91], v[176:179]
    v_mfma_f32_16x16x32_bf16 v[196:199], v[100:103], a[88:91], v[196:199]
    v_mfma_f32_16x16x32_bf16 v[180:183], v[96:99], a[92:95], v[180:183]
    v_mfma_f32_16x16x32_bf16 v[200:203], v[100:103], a[92:95], v[200:203]
    v_mfma_f32_16x16x32_bf16 v[184:187], v[96:99], a[96:99], v[184:187]
    v_mfma_f32_16x16x32_bf16 v[204:207], v[100:103], a[96:99], v[204:207]
    v_mfma_f32_16x16x32_bf16 v[168:171], v[104:107], a[100:103], v[168:171]
    v_mfma_f32_16x16x32_bf16 v[188:191], v[108:111], a[100:103], v[188:191]
    v_mfma_f32_16x16x32_bf16 v[172:175], v[104:107], a[104:107], v[172:175]
    v_mfma_f32_16x16x32_bf16 v[192:195], v[108:111], a[104:107], v[192:195]
    v_mfma_f32_16x16x32_bf16 v[176:179], v[104:107], a[108:111], v[176:179]
    v_mfma_f32_16x16x32_bf16 v[196:199], v[108:111], a[108:111], v[196:199]
    v_mfma_f32_16x16x32_bf16 v[180:183], v[104:107], a[112:115], v[180:183]
    v_mfma_f32_16x16x32_bf16 v[200:203], v[108:111], a[112:115], v[200:203]
    v_mfma_f32_16x16x32_bf16 v[184:187], v[104:107], a[116:119], v[184:187]
    v_mfma_f32_16x16x32_bf16 v[204:207], v[108:111], a[116:119], v[204:207]
    v_mfma_f32_16x16x32_bf16 v[168:171], v[112:115], a[120:123], v[168:171]
    v_mfma_f32_16x16x32_bf16 v[188:191], v[116:119], a[120:123], v[188:191]
    v_mfma_f32_16x16x32_bf16 v[172:175], v[112:115], a[124:127], v[172:175]
    v_mfma_f32_16x16x32_bf16 v[192:195], v[116:119], a[124:127], v[192:195]
    v_mfma_f32_16x16x32_bf16 v[176:179], v[112:115], a[128:131], v[176:179]
    v_mfma_f32_16x16x32_bf16 v[196:199], v[116:119], a[128:131], v[196:199]
    v_mfma_f32_16x16x32_bf16 v[180:183], v[112:115], a[132:135], v[180:183]
    v_mfma_f32_16x16x32_bf16 v[200:203], v[116:119], a[132:135], v[200:203]
    v_mfma_f32_16x16x32_bf16 v[184:187], v[112:115], a[136:139], v[184:187]
    v_mfma_f32_16x16x32_bf16 v[204:207], v[116:119], a[136:139], v[204:207]
    v_mfma_f32_16x16x32_bf16 v[168:171], v[120:123], a[140:143], v[168:171]
    v_mfma_f32_16x16x32_bf16 v[188:191], v[124:127], a[140:143], v[188:191]
    v_mfma_f32_16x16x32_bf16 v[172:175], v[120:123], a[144:147], v[172:175]
    v_mfma_f32_16x16x32_bf16 v[192:195], v[124:127], a[144:147], v[192:195]
    v_mfma_f32_16x16x32_bf16 v[176:179], v[120:123], a[148:151], v[176:179]
    v_mfma_f32_16x16x32_bf16 v[196:199], v[124:127], a[148:151], v[196:199]
    v_mfma_f32_16x16x32_bf16 v[180:183], v[120:123], a[152:155], v[180:183]
    v_mfma_f32_16x16x32_bf16 v[200:203], v[124:127], a[152:155], v[200:203]
    v_mfma_f32_16x16x32_bf16 v[184:187], v[120:123], a[156:159], v[184:187]
    v_mfma_f32_16x16x32_bf16 v[204:207], v[124:127], a[156:159], v[204:207]
    s_nop 7
    v_cvt_pk_bf16_f32 v208, v168, v169
    v_cvt_pk_bf16_f32 v209, v170, v171
    v_cvt_pk_bf16_f32 v210, v188, v189
    v_cvt_pk_bf16_f32 v211, v190, v191
    s_lshr_b32 s31, s73, 1
    s_xor_b32 s31, s31, 3
    s_mul_i32 s31, s31, 81920
    s_add_u32 s31, s31, s71
    buffer_store_dwordx4 v[208:211], v33, s[92:95], s31 offen offset:0 sc0 sc1
    v_cvt_pk_bf16_f32 v212, v172, v173
    v_cvt_pk_bf16_f32 v213, v174, v175
    v_cvt_pk_bf16_f32 v214, v192, v193
    v_cvt_pk_bf16_f32 v215, v194, v195
    buffer_store_dwordx4 v[212:215], v33, s[92:95], s31 offen offset:1024 sc0 sc1
    v_cvt_pk_bf16_f32 v216, v176, v177
    v_cvt_pk_bf16_f32 v217, v178, v179
    v_cvt_pk_bf16_f32 v218, v196, v197
    v_cvt_pk_bf16_f32 v219, v198, v199
    buffer_store_dwordx4 v[216:219], v33, s[92:95], s31 offen offset:2048 sc0 sc1
    v_cvt_pk_bf16_f32 v220, v180, v181
    v_cvt_pk_bf16_f32 v221, v182, v183
    v_cvt_pk_bf16_f32 v222, v200, v201
    v_cvt_pk_bf16_f32 v223, v202, v203
    buffer_store_dwordx4 v[220:223], v33, s[92:95], s31 offen offset:3072 sc0 sc1
    v_cvt_pk_bf16_f32 v224, v184, v185
    v_cvt_pk_bf16_f32 v225, v186, v187
    v_cvt_pk_bf16_f32 v226, v204, v205
    v_cvt_pk_bf16_f32 v227, v206, v207
    s_add_u32 s31, s31, 4096
    buffer_store_dwordx4 v[224:227], v33, s[92:95], s31 offen offset:0 sc0 sc1
    s_mov_b32 s75, 400000
L_tag19:
    v_readfirstlane_b32 s29, v34
    s_nop 3
    s_cmp_lg_u32 s29, 0
    s_cbranch_scc1 L_tagd20
    s_sub_u32 s75, s75, 1
    s_cbranch_scc1 L_tagd20
    s_sleep 2
    v_mov_b32 v1, 0
    buffer_load_dwordx2 v[34:35], v1, s[76:79], 0 offen sc0 sc1
    s_waitcnt vmcnt(0)
    s_branch L_tag19
L_tagd20:
    s_lshl_b32 s29, s69, 2
    s_add_u32 s30, s29, s24
    s_lshl_b32 s30, s30, 4
    s_add_u32 s30, s30, s70
    s_lshl_b32 s30, s30, 3
    v_mov_b32 v1, 0
    s_mov_b32 s96, s56
    s_and_b32 s97, s57, 0xffff
    s_mov_b32 s98, 1310720
    s_mov_b32 s99, 0x20000
    v_and_b32 v4, 15, v0
    v_lshrrev_b32 v5, 4, v0
    v_lshlrev_b32 v6, 3, v4
    v_lshlrev_b32 v4, 11, v4
    v_lshl_add_u32 v4, v5, 3, v4
    s_waitcnt vmcnt(0)
    s_mov_b64 exec, 1
    buffer_store_dwordx2 v[34:35], v1, s[80:83], s30 offen sc0 sc1
    s_mov_b64 exec, -1
    s_and_b32 s29, s64, s65
    s_cmp_eq_u32 s29, 1
    s_cbranch_scc1 L_fin
    s_mov_b32 s65, 0
    s_mov_b32 s28, s24
    s_mov_b32 s32, s64
L_rp21:
    s_lshl_b32 s29, s69, 2
    s_lshr_b32 s30, s70, 2
    s_add_u32 s29, s29, s30
    s_lshl_b32 s29, s29, 7
    s_mov_b32 s75, 400000
L_pf22:
    buffer_load_dwordx2 v[2:3], v6, s[80:83], s29 offen sc0 sc1
    s_waitcnt vmcnt(0)
    v_cmp_ne_u64 vcc, v[2:3], v[34:35]
    s_nop 4
    s_cbranch_vccz L_pfd23
    s_sub_u32 s75, s75, 1
    s_cbranch_scc1 L_pfd23
    s_sleep 1
    s_branch L_pf22
L_pfd23:
    s_mul_i32 s30, s70, 81920
    s_lshl_b32 s29, s28, 10
    s_add_u32 s30, s30, s29
    buffer_load_dwordx4 v[64:67], v33, s[92:95], s30 offen sc0 sc1
    s_add_u32 s30, s30, 5120
    buffer_load_dwordx4 v[68:71], v33, s[92:95], s30 offen sc0 sc1
    s_add_u32 s30, s30, 5120
    buffer_load_dwordx4 v[72:75], v33, s[92:95], s30 offen sc0 sc1
    s_add_u32 s30, s30, 5120
    buffer_load_dwordx4 v[76:79], v33, s[92:95], s30 offen sc0 sc1
    s_add_u32 s30, s30, 5120
    buffer_load_dwordx4 v[80:83], v33, s[92:95], s30 offen sc0 sc1
    s_add_u32 s30, s30, 5120
    buffer_load_dwordx4 v[84:87], v33, s[92:95], s30 offen sc0 sc1
    s_add_u32 s30, s30, 5120
    buffer_load_dwordx4 v[88:91], v33, s[92:95], s30 offen sc0 sc1
    s_add_u32 s30, s30, 5120
    buffer_load_dwordx4 v[92:95], v33, s[92:95], s30 offen sc0 sc1
    s_add_u32 s30, s30, 5120
    buffer_load_dwordx4 v[96:99], v33, s[92:95], s30 offen sc0 sc1
    s_add_u32 s30, s30, 5120
    buffer_load_dwordx4 v[100:103], v33, s[92:95], s30 offen sc0 sc1
    s_add_u32 s30, s30, 5120
    buffer_load_dwordx4 v[104:107], v33, s[92:95], s30 offen sc0 sc1
    s_add_u32 s30, s30, 5120
    buffer_load_dwordx4 v[108:111], v33, s[92:95], s30 offen sc0 sc1
    s_add_u32 s30, s30, 5120
    buffer_load_dwordx4 v[112:115], v33, s[92:95], s30 offen sc0 sc1
    s_add_u32 s30, s30, 5120
    buffer_load_dwordx4 v[116:119], v33, s[92:95], s30 offen sc0 sc1
    s_add_u32 s30, s30, 5120
    buffer_load_dwordx4 v[120:123], v33, s[92:95], s30 offen sc0 sc1
    s_add_u32 s30, s30, 5120
    buffer_load_dwordx4 v[124:127], v33, s[92:95], s30 offen sc0 sc1
    s_add_u32 s30, s30, 5120
    s_mul_i32 s31, s63, 163840
    s_lshl_b32 s29, s28, 15
    s_add_u32 s31, s31, s29
    s_lshl_b32 s29, s32, 10
    s_add_u32 s31, s31, s29
    s_lshl_b32 s29, s70, 6
    s_add_u32 s31, s31, s29
    s_waitcnt vmcnt(15)
    v_lshlrev_b32 v140, 16, v64
    v_and_b32 v141, 0xffff0000, v64
    v_lshlrev_b32 v142, 16, v65
    v_and_b32 v143, 0xffff0000, v65
    v_lshlrev_b32 v144, 16, v66
    v_and_b32 v145, 0xffff0000, v66
    v_lshlrev_b32 v146, 16, v67
    v_and_b32 v147, 0xffff0000, v67
    s_waitcnt vmcnt(14)
    v_lshlrev_b32 v150, 16, v68
    v_and_b32 v151, 0xffff0000, v68
    v_pk_add_f32 v[140:141], v[140:141], v[150:151]
    v_lshlrev_b32 v152, 16, v69
    v_and_b32 v153, 0xffff0000, v69
    v_pk_add_f32 v[142:143], v[142:143], v[152:153]
    v_lshlrev_b32 v154, 16, v70
    v_and_b32 v155, 0xffff0000, v70
    v_pk_add_f32 v[144:145], v[144:145], v[154:155]
    v_lshlrev_b32 v156, 16, v71
    v_and_b32 v157, 0xffff0000, v71
    v_pk_add_f32 v[146:147], v[146:147], v[156:157]
    s_waitcnt vmcnt(13)
    v_lshlrev_b32 v150, 16, v72
    v_and_b32 v151, 0xffff0000, v72
    v_pk_add_f32 v[140:141], v[140:141], v[150:151]
    v_lshlrev_b32 v152, 16, v73
    v_and_b32 v153, 0xffff0000, v73
    v_pk_add_f32 v[142:143], v[142:143], v[152:153]
    v_lshlrev_b32 v154, 16, v74
    v_and_b32 v155, 0xffff0000, v74
    v_pk_add_f32 v[144:145], v[144:145], v[154:155]
    v_lshlrev_b32 v156, 16, v75
    v_and_b32 v157, 0xffff0000, v75
    v_pk_add_f32 v[146:147], v[146:147], v[156:157]
    s_waitcnt vmcnt(12)
    v_lshlrev_b32 v150, 16, v76
    v_and_b32 v151, 0xffff0000, v76
    v_pk_add_f32 v[140:141], v[140:141], v[150:151]
    v_lshlrev_b32 v152, 16, v77
    v_and_b32 v153, 0xffff0000, v77
    v_pk_add_f32 v[142:143], v[142:143], v[152:153]
    v_lshlrev_b32 v154, 16, v78
    v_and_b32 v155, 0xffff0000, v78
    v_pk_add_f32 v[144:145], v[144:145], v[154:155]
    v_lshlrev_b32 v156, 16, v79
    v_and_b32 v157, 0xffff0000, v79
    v_pk_add_f32 v[146:147], v[146:147], v[156:157]
    s_waitcnt vmcnt(11)
    v_lshlrev_b32 v150, 16, v80
    v_and_b32 v151, 0xffff0000, v80
    v_pk_add_f32 v[140:141], v[140:141], v[150:151]
    v_lshlrev_b32 v152, 16, v81
    v_and_b32 v153, 0xffff0000, v81
    v_pk_add_f32 v[142:143], v[142:143], v[152:153]
    v_lshlrev_b32 v154, 16, v82
    v_and_b32 v155, 0xffff0000, v82
    v_pk_add_f32 v[144:145], v[144:145], v[154:155]
    v_lshlrev_b32 v156, 16, v83
    v_and_b32 v157, 0xffff0000, v83
    v_pk_add_f32 v[146:147], v[146:147], v[156:157]
    s_waitcnt vmcnt(10)
    v_lshlrev_b32 v150, 16, v84
    v_and_b32 v151, 0xffff0000, v84
    v_pk_add_f32 v[140:141], v[140:141], v[150:151]
    v_lshlrev_b32 v152, 16, v85
    v_and_b32 v153, 0xffff0000, v85
    v_pk_add_f32 v[142:143], v[142:143], v[152:153]
    v_lshlrev_b32 v154, 16, v86
    v_and_b32 v155, 0xffff0000, v86
    v_pk_add_f32 v[144:145], v[144:145], v[154:155]
    v_lshlrev_b32 v156, 16, v87
    v_and_b32 v157, 0xffff0000, v87
    v_pk_add_f32 v[146:147], v[146:147], v[156:157]
    s_waitcnt vmcnt(9)
    v_lshlrev_b32 v150, 16, v88
    v_and_b32 v151, 0xffff0000, v88
    v_pk_add_f32 v[140:141], v[140:141], v[150:151]
    v_lshlrev_b32 v152, 16, v89
    v_and_b32 v153, 0xffff0000, v89
    v_pk_add_f32 v[142:143], v[142:143], v[152:153]
    v_lshlrev_b32 v154, 16, v90
    v_and_b32 v155, 0xffff0000, v90
    v_pk_add_f32 v[144:145], v[144:145], v[154:155]
    v_lshlrev_b32 v156, 16, v91
    v_and_b32 v157, 0xffff0000, v91
    v_pk_add_f32 v[146:147], v[146:147], v[156:157]
    s_waitcnt vmcnt(8)
    v_lshlrev_b32 v150, 16, v92
    v_and_b32 v151, 0xffff0000, v92
    v_pk_add_f32 v[140:141], v[140:141], v[150:151]
    v_lshlrev_b32 v152, 16, v93
    v_and_b32 v153, 0xffff0000, v93
    v_pk_add_f32 v[142:143], v[142:143], v[152:153]
    v_lshlrev_b32 v154, 16, v94
    v_and_b32 v155, 0xffff0000, v94
    v_pk_add_f32 v[144:145], v[144:145], v[154:155]
    v_lshlrev_b32 v156, 16, v95
    v_and_b32 v157, 0xffff0000, v95
    v_pk_add_f32 v[146:147], v[146:147], v[156:157]
    s_waitcnt vmcnt(7)
    v_lshlrev_b32 v150, 16, v96
    v_and_b32 v151, 0xffff0000, v96
    v_pk_add_f32 v[140:141], v[140:141], v[150:151]
    v_lshlrev_b32 v152, 16, v97
    v_and_b32 v153, 0xffff0000, v97
    v_pk_add_f32 v[142:143], v[142:143], v[152:153]
    v_lshlrev_b32 v154, 16, v98
    v_and_b32 v155, 0xffff0000, v98
    v_pk_add_f32 v[144:145], v[144:145], v[154:155]
    v_lshlrev_b32 v156, 16, v99
    v_and_b32 v157, 0xffff0000, v99
    v_pk_add_f32 v[146:147], v[146:147], v[156:157]
    s_waitcnt vmcnt(6)
    v_lshlrev_b32 v150, 16, v100
    v_and_b32 v151, 0xffff0000, v100
    v_pk_add_f32 v[140:141], v[140:141], v[150:151]
    v_lshlrev_b32 v152, 16, v101
    v_and_b32 v153, 0xffff0000, v101
    v_pk_add_f32 v[142:143], v[142:143], v[152:153]
    v_lshlrev_b32 v154, 16, v102
    v_and_b32 v155, 0xffff0000, v102
    v_pk_add_f32 v[144:145], v[144:145], v[154:155]
    v_lshlrev_b32 v156, 16, v103
    v_and_b32 v157, 0xffff0000, v103
    v_pk_add_f32 v[146:147], v[146:147], v[156:157]
    s_waitcnt vmcnt(5)
    v_lshlrev_b32 v150, 16, v104
    v_and_b32 v151, 0xffff0000, v104
    v_pk_add_f32 v[140:141], v[140:141], v[150:151]
    v_lshlrev_b32 v152, 16, v105
    v_and_b32 v153, 0xffff0000, v105
    v_pk_add_f32 v[142:143], v[142:143], v[152:153]
    v_lshlrev_b32 v154, 16, v106
    v_and_b32 v155, 0xffff0000, v106
    v_pk_add_f32 v[144:145], v[144:145], v[154:155]
    v_lshlrev_b32 v156, 16, v107
    v_and_b32 v157, 0xffff0000, v107
    v_pk_add_f32 v[146:147], v[146:147], v[156:157]
    s_waitcnt vmcnt(4)
    v_lshlrev_b32 v150, 16, v108
    v_and_b32 v151, 0xffff0000, v108
    v_pk_add_f32 v[140:141], v[140:141], v[150:151]
    v_lshlrev_b32 v152, 16, v109
    v_and_b32 v153, 0xffff0000, v109
    v_pk_add_f32 v[142:143], v[142:143], v[152:153]
    v_lshlrev_b32 v154, 16, v110
    v_and_b32 v155, 0xffff0000, v110
    v_pk_add_f32 v[144:145], v[144:145], v[154:155]
    v_lshlrev_b32 v156, 16, v111
    v_and_b32 v157, 0xffff0000, v111
    v_pk_add_f32 v[146:147], v[146:147], v[156:157]
    s_waitcnt vmcnt(3)
    v_lshlrev_b32 v150, 16, v112
    v_and_b32 v151, 0xffff0000, v112
    v_pk_add_f32 v[140:141], v[140:141], v[150:151]
    v_lshlrev_b32 v152, 16, v113
    v_and_b32 v153, 0xffff0000, v113
    v_pk_add_f32 v[142:143], v[142:143], v[152:153]
    v_lshlrev_b32 v154, 16, v114
    v_and_b32 v155, 0xffff0000, v114
    v_pk_add_f32 v[144:145], v[144:145], v[154:155]
    v_lshlrev_b32 v156, 16, v115
    v_and_b32 v157, 0xffff0000, v115
    v_pk_add_f32 v[146:147], v[146:147], v[156:157]
    s_waitcnt vmcnt(2)
    v_lshlrev_b32 v150, 16, v116
    v_and_b32 v151, 0xffff0000, v116
    v_pk_add_f32 v[140:141], v[140:141], v[150:151]
    v_lshlrev_b32 v152, 16, v117
    v_and_b32 v153, 0xffff0000, v117
    v_pk_add_f32 v[142:143], v[142:143], v[152:153]
    v_lshlrev_b32 v154, 16, v118
    v_and_b32 v155, 0xffff0000, v118
    v_pk_add_f32 v[144:145], v[144:145], v[154:155]
    v_lshlrev_b32 v156, 16, v119
    v_and_b32 v157, 0xffff0000, v119
    v_pk_add_f32 v[146:147], v[146:147], v[156:157]
    s_waitcnt vmcnt(1)
    v_lshlrev_b32 v150, 16, v120
    v_and_b32 v151, 0xffff0000, v120
    v_pk_add_f32 v[140:141], v[140:141], v[150:151]
    v_lshlrev_b32 v152, 16, v121
    v_and_b32 v153, 0xffff0000, v121
    v_pk_add_f32 v[142:143], v[142:143], v[152:153]
    v_lshlrev_b32 v154, 16, v122
    v_and_b32 v155, 0xffff0000, v122
    v_pk_add_f32 v[144:145], v[144:145], v[154:155]
    v_lshlrev_b32 v156, 16, v123
    v_and_b32 v157, 0xffff0000, v123
    v_pk_add_f32 v[146:147], v[146:147], v[156:157]
    s_waitcnt vmcnt(0)
    v_lshlrev_b32 v150, 16, v124
    v_and_b32 v151, 0xffff0000, v124
    v_pk_add_f32 v[140:141], v[140:141], v[150:151]
    v_lshlrev_b32 v152, 16, v125
    v_and_b32 v153, 0xffff0000, v125
    v_pk_add_f32 v[142:143], v[142:143], v[152:153]
    v_lshlrev_b32 v154, 16, v126
    v_and_b32 v155, 0xffff0000, v126
    v_pk_add_f32 v[144:145], v[144:145], v[154:155]
    v_lshlrev_b32 v156, 16, v127
    v_and_b32 v157, 0xffff0000, v127
    v_pk_add_f32 v[146:147], v[146:147], v[156:157]
    v_cvt_pk_bf16_f32 v160, v140, v141
    v_cvt_pk_bf16_f32 v161, v142, v143
    v_cvt_pk_bf16_f32 v162, v144, v145
    v_cvt_pk_bf16_f32 v163, v146, v147
    buffer_store_dwordx2 v[160:161], v4, s[96:99], s31 offen
    buffer_store_dwordx2 v[162:163], v4, s[96:99], s31 offen offset:32
    s_cmp_eq_u32 s64, 1
    s_cbranch_scc1 L_fin
    s_cmp_eq_u32 s65, 1
    s_cbranch_scc1 L_fin
    s_mov_b32 s65, 1
    s_add_u32 s28, s24, 1
    s_cmp_eq_u32 s24, 0
    s_cselect_b32 s28, 4, s28
    s_cselect_b32 s32, 0, 1
    s_lshl_b32 s29, s32, 3
    s_add_u32 s69, s29, s63
    s_mul_i32 s29, s69, 1310720
    s_add_u32 s29, s29, 0
    s_add_u32 s92, s60, s29
    s_addc_u32 s93, s61, 0
    s_and_b32 s93, s93, 0xffff
    s_mov_b32 s94, 1310720
    s_mov_b32 s95, 0x20000
    s_branch L_rp21
L_fin:
L_exit:
    s_endpgm
.section .rodata,"a"
.p2align 6
.amdhsa_kernel concat_heads__gqa_block_cached__mha_block_cached__near_ridge_kernel
  .amdhsa_next_free_vgpr 512
  .amdhsa_next_free_sgpr 102
  .amdhsa_accum_offset 256
  .amdhsa_group_segment_fixed_size 0
  .amdhsa_kernarg_size 104
  .amdhsa_user_sgpr_count 2
  .amdhsa_user_sgpr_kernarg_segment_ptr 1
  .amdhsa_system_sgpr_workgroup_id_x 1
.end_amdhsa_kernel
```
